```python
import torch

def _softmax(x, axis=-1):
    return torch.softmax(x, dim=axis)
def _gelu(x):
    return torch.nn.functional.gelu(x, approximate="tanh")
def _silu(x):
    return torch.nn.functional.silu(x)
def _sigmoid(x):
    return torch.sigmoid(x)
def _layernorm(x, axis=-1, eps=1e-5):
    m = x.mean(dim=axis, keepdim=True)
    v = x.var(dim=axis, keepdim=True, unbiased=False)
    return (x - m) / torch.sqrt(v + eps)
def _scatter_add(tgt, idx, src, axis=0):
    return tgt.clone().index_add_(axis, idx, src)
def _segment_sum(src, seg, n):
    out = torch.zeros((n,) + src.shape[1:], dtype=src.dtype)
    return out.index_add_(0, seg, src)
def _pad(x, pw):
    flat = tuple(v for pair in reversed(pw) for v in pair)
    return torch.nn.functional.pad(x, flat)

kernel_name = 'recurrent_scan__mha_block_cached__glu_gated_glu__decode'

def setup_inputs():

    _w = (lambda a: (lambda t: t.to(torch.bfloat16) if t.is_floating_point() else t)(torch.as_tensor(a)))
    def _A_setup():
        B, Sq, D = 1, 1, 512
        H, Sk, Dh = 32, 8192, 128
        return {
            "x": _w((lambda *s: torch.randn(*s, dtype=torch.bfloat16) * 0.05)(B, Sq, D)),
            "k_cache": _w((lambda *s: torch.randn(*s, dtype=torch.bfloat16) * 0.8)(B, H, Sk, Dh)),
            "v_cache": _w((lambda *s: torch.randn(*s, dtype=torch.bfloat16) * 0.8)(B, H, Sk, Dh)),
            "wq": _w((lambda *s: torch.randn(*s, dtype=torch.bfloat16) * 0.8)(D, H * Dh) * (D ** -0.5)),
            "wo": _w((lambda *s: torch.randn(*s, dtype=torch.bfloat16) * 0.8)(H * Dh, D) * ((H * Dh) ** -0.5)),
        }
    _A_in = _A_setup()

    def _B_setup():
        B, S, D, F = 1, 1, 512, 1376
        return {
            "x": _w((lambda *s: torch.randn(*s, dtype=torch.bfloat16) * 0.05)(B, S, D)),
            "w_gate": _w((lambda *s: torch.randn(*s, dtype=torch.bfloat16) * 0.8)(D, F)),
            "w_up": _w((lambda *s: torch.randn(*s, dtype=torch.bfloat16) * 0.2)(D, F)),
            "w_down": _w((lambda *s: torch.randn(*s, dtype=torch.bfloat16) * 0.2)(F, D)),
        }
    _B_in = _B_setup()

    return {
        "A_x": _A_in["x"],
        "A_k_cache": _A_in["k_cache"],
        "A_v_cache": _A_in["v_cache"],
        "A_wq": _A_in["wq"],
        "A_wo": _A_in["wo"],
        "B_x": _B_in["x"],
        "B_w_gate": _B_in["w_gate"],
        "B_w_up": _B_in["w_up"],
        "B_w_down": _B_in["w_down"],
    }

def reference(A_x, A_k_cache, A_v_cache, A_wq, A_wo, B_x, B_w_gate, B_w_up, B_w_down):
    def _A_ref(x, k_cache, v_cache, wq, wo):
        B, Sq, D = x.shape
        H, Dh = 32, 128
        q = (lambda x, *d: x.permute(*d))((x @ wq).reshape(B, Sq, H, Dh), 0, 2, 1, 3)
        scores = torch.einsum("bhqd,bhkd->bhqk", q, k_cache) * (Dh ** -0.5)
        p = _softmax(scores, axis=-1)
        o = torch.einsum("bhqk,bhkd->bhqd", p, v_cache)
        return (lambda x, *d: x.permute(*d))(o, 0, 2, 1, 3).reshape(B, Sq, H * Dh) @ wo

    def _B_ref(x, w_gate, w_up, w_down):
        g = torch.einsum("bsd,df->bsf", x, w_gate)
        u = torch.einsum("bsd,df->bsf", x, w_up)
        h = _sigmoid(g) * u
        return torch.einsum("bsf,fd->bsd", h, w_down)

    x = A_x
    xn = _layernorm(x, axis=-1)
    s = _A_ref(xn, A_k_cache, A_v_cache, A_wq, A_wo)
    g = _silu(_B_ref(xn, B_w_gate, B_w_up, B_w_down))
    return x + s * g
```

```asm
; @launch grid=(256,1,1) block=(256,1,1) lds=22272
.amdgcn_target "amdgcn-amd-amdhsa--gfx950"
.text
.globl recurrent_scan__mha_block_cached__glu_gated_glu__decode_kernel
.p2align 8
.type recurrent_scan__mha_block_cached__glu_gated_glu__decode_kernel,@function
recurrent_scan__mha_block_cached__glu_gated_glu__decode_kernel:
    s_load_dwordx2 s[12:13], s[0:1], 8
    s_load_dwordx2 s[8:9], s[0:1], 0
    s_load_dwordx2 s[16:17], s[0:1], 24
    s_load_dwordx2 s[28:29], s[0:1], 48
    s_load_dwordx2 s[32:33], s[0:1], 56
    s_load_dwordx8 s[72:79], s[0:1], 64
    s_load_dwordx2 s[20:21], s[0:1], 16
    s_cmp_ge_u32 s2, 256
    s_cbranch_scc1 L_end
    v_lshrrev_b32 v3, 6, v0
    v_and_b32 v0, 63, v0
    s_and_b32 s7, s2, 7
    v_readfirstlane_b32 s3, v3
    s_lshr_b32 s6, s2, 3
    s_lshl_b32 s4, s7, 2
    s_lshr_b32 s5, s6, 3
    s_add_u32 s4, s4, s5
    s_and_b32 s5, s6, 7
    s_lshl_b32 s52, s5, 18
    s_lshl_b32 s53, s4, 21
    s_add_u32 s52, s52, s53
    s_mul_i32 s53, s3, 1024
    s_add_u32 s52, s52, s53
    v_lshlrev_b32 v62, 4, v0
    v_add_u32 v1, s52, v62
    s_mov_b32 s14, 0x4000000
    s_mov_b32 s15, 0x20000
    s_lshl_b32 s57, s5, 15
L_split:
    s_waitcnt lgkmcnt(0)
    buffer_load_dwordx4 v[96:99], v1, s[12:15], s57 offen offset:0 nt
    s_xor_b32 s56, s57, 4096
    buffer_load_dwordx4 v[100:103], v1, s[12:15], s56 offen offset:0 nt
    s_xor_b32 s56, s57, 8192
    buffer_load_dwordx4 v[104:107], v1, s[12:15], s56 offen offset:0 nt
    s_xor_b32 s56, s57, 12288
    buffer_load_dwordx4 v[108:111], v1, s[12:15], s56 offen offset:0 nt
    s_xor_b32 s56, s57, 16384
    buffer_load_dwordx4 v[112:115], v1, s[12:15], s56 offen offset:0 nt
    s_xor_b32 s56, s57, 20480
    buffer_load_dwordx4 v[116:119], v1, s[12:15], s56 offen offset:0 nt
    s_xor_b32 s56, s57, 24576
    buffer_load_dwordx4 v[120:123], v1, s[12:15], s56 offen offset:0 nt
    s_mov_b32 s10, 1024
    s_mov_b32 s11, 0x20000
    s_mov_b32 s18, 4194304
    s_mov_b32 s19, 0x20000
    buffer_load_dwordx4 v[40:43], v62, s[8:11], 0 offen
    v_lshrrev_b32 v61, 4, v0
    v_and_b32 v60, 15, v0
    s_lshl_b32 s52, s5, 2
    s_add_u32 s54, s52, s3
    s_lshl_b32 s52, s54, 17
    s_lshl_b32 s53, s4, 8
    s_add_u32 s52, s52, s53
    v_lshlrev_b32 v2, 15, v61
    v_lshl_add_u32 v2, v60, 4, v2
    v_add_u32 v2, s52, v2
    s_movk_i32 s55, 0x2000
    s_movk_i32 s53, 0x4000
    s_movk_i32 s58, 0x6000
    buffer_load_dwordx4 a[240:243], v2, s[16:19], 0 offen nt
    buffer_load_dwordx4 a[244:247], v2, s[16:19], s55 offen nt
    buffer_load_dwordx4 a[248:251], v2, s[16:19], s53 offen nt
    buffer_load_dwordx4 a[252:255], v2, s[16:19], s58 offen nt
    s_xor_b32 s56, s57, 28672
    buffer_load_dwordx4 v[124:127], v1, s[12:15], s56 offen offset:0 nt
    s_lshl_b32 s52, s7, 4
    s_add_u32 s52, s52, s6
    s_lshr_b32 s53, s7, 1
    s_mul_i32 s53, s53, 22
    s_add_u32 s53, s53, s6
    s_add_u32 s53, s53, 128
    s_cmp_lt_u32 s6, 22
    s_cselect_b32 s53, s53, 0xff
    s_bitcmp0_b32 s7, 0
    s_cselect_b32 s6, s52, s53
    s_cmp_lt_u32 s6, 172
    s_cselect_b32 s30, 1409024, 0
    s_cselect_b32 s59, 0, 2147483648
    s_mov_b32 s34, s30
    s_mov_b32 s31, 0x20000
    s_mov_b32 s35, 0x20000
    s_lshl_b32 s53, s3, 10
    s_add_u32 s53, s53, 5632
    v_add_u32 v47, s53, v62
    s_lshl_b32 s52, s54, 5
    s_add_u32 s52, s52, s53
    v_lshl_add_u32 v53, v61, 3, s52
    s_and_b32 s52, s6, 3
    s_lshl_b32 s52, s52, 2
    s_add_u32 s52, s52, s3
    s_lshl_b32 s52, s52, 5
    v_lshrrev_b32 v3, 2, v0
    v_add_u32 v3, s52, v3
    v_lshl_add_u32 v54, v3, 1, s53
    v_mul_u32_u24 v3, 2752, v3
    v_and_b32 v50, 3, v0
    v_lshl_add_u32 v3, v50, 4, v3
    s_lshr_b32 s52, s6, 2
    s_lshl_b32 s52, s52, 6
    v_add_u32 v63, s52, v3
    s_mov_b32 s84, 44032
    s_load_dword s82, s[78:79], 135168
    s_load_dwordx2 s[24:25], s[0:1], 32
    s_mov_b32 s22, 0x4000000
    s_mov_b32 s23, 0x20000
    s_mov_b32 s26, 4194304
    s_mov_b32 s27, 0x20000
    s_mov_b32 s36, s72
    s_mov_b32 s37, s73
    s_mov_b32 s38, s30
    s_mov_b32 s39, 0x20000
    s_mov_b32 s40, s78
    s_mov_b32 s41, s79
    s_mov_b32 s42, 0x10000000
    s_mov_b32 s43, 0x20000
    s_mov_b32 s44, s74
    s_mov_b32 s45, s75
    s_mov_b32 s46, 1024
    s_mov_b32 s47, 0x20000
    s_mov_b32 s60, 0x3fb8aa3b
    s_mov_b32 s61, 0xbfb8aa3b
    s_mov_b32 s64, 0xffffff00
    s_mov_b32 s81, 0x100000
    s_lshl_b32 s62, s4, 3
    s_add_u32 s62, s62, s5
    s_lshl_b32 s52, s54, 11
    s_lshl_b32 s53, s4, 6
    s_add_u32 s63, s52, s53
    s_add_u32 s63, s63, 327680
    s_sub_u32 s52, s2, 192
    s_lshr_b32 s53, s52, 3
    s_lshl_b32 s53, s53, 2
    s_and_b32 s75, s2, 2
    s_add_u32 s75, s75, s53
    s_add_u32 s75, s75, s3
    s_sub_u32 s75, s75, 1
    s_and_b32 s52, s52, 0xffffffc5
    s_sub_u32 s53, s3, 1
    s_lshr_b32 s53, s53, 1
    s_xor_b32 s52, s52, 1
    s_or_b32 s52, s52, s53
    s_cselect_b32 s80, 2147483648, 0
    s_and_b32 s75, s75, 31
    s_nop 0
    s_cmp_eq_u32 s3, 0
    s_cselect_b32 s65, 0, 2147483648
    v_and_b32 v50, 1, v60
    v_lshlrev_b32 v50, 4, v50
    v_mov_b32 v51, 0xffff
    v_lshlrev_b32 v51, v50, v51
    v_lshrrev_b32 v52, 1, v60
    v_cmp_eq_u32 s[66:67], 0, v52
    v_cmp_eq_u32 s[68:69], 1, v52
    v_cmp_eq_u32 s[70:71], 2, v52
    v_cmp_eq_u32 s[72:73], 3, v52
    v_cndmask_b32 v4, 0, v51, s[66:67]
    v_cndmask_b32 v5, 0, v51, s[68:69]
    v_cndmask_b32 v6, 0, v51, s[70:71]
    v_cndmask_b32 v7, 0, v51, s[72:73]
    s_waitcnt vmcnt(5)
    ds_write_b128 v47, v[40:43]
    v_lshlrev_b32 v80, 16, v40
    v_and_b32 v81, 0xffff0000, v40
    v_lshlrev_b32 v82, 16, v41
    v_and_b32 v83, 0xffff0000, v41
    v_lshlrev_b32 v84, 16, v42
    v_and_b32 v85, 0xffff0000, v42
    v_lshlrev_b32 v86, 16, v43
    v_and_b32 v87, 0xffff0000, v43
    v_add_f32 v48, v80, v81
    v_add_f32 v49, v82, v83
    v_add_f32 v50, v84, v85
    v_add_f32 v51, v86, v87
    v_add_f32 v48, v48, v49
    v_add_f32 v50, v50, v51
    v_add_f32 v48, v48, v50
    s_waitcnt lgkmcnt(0)
    ds_read_b64 v[44:45], v53
    ds_read_u16 v46, v54
    ds_read_u16 v47, v54 offset:32
    v_add_f32_dpp v48, v48, v48 row_ror:8 row_mask:0xf bank_mask:0xf
    s_nop 1
    v_add_f32_dpp v48, v48, v48 row_ror:4 row_mask:0xf bank_mask:0xf
    s_nop 1
    v_add_f32_dpp v48, v48, v48 row_ror:2 row_mask:0xf bank_mask:0xf
    s_nop 1
    v_add_f32_dpp v48, v48, v48 row_ror:1 row_mask:0xf bank_mask:0xf
    s_nop 1
    v_add_f32_dpp v48, v48, v48 row_bcast:15 row_mask:0xa bank_mask:0xf
    s_nop 1
    v_add_f32_dpp v48, v48, v48 row_bcast:31 row_mask:0xc bank_mask:0xf
    s_xor_b32 s56, s57, 32768
    buffer_load_dwordx4 v[128:131], v1, s[12:15], s56 offen offset:0 nt
    v_mul_f32 v48, 0x3b000000, v48
    s_nop 0
    v_readlane_b32 s52, v48, 63
    s_nop 1
    v_subrev_f32 v80, s52, v80
    v_subrev_f32 v81, s52, v81
    v_subrev_f32 v82, s52, v82
    v_subrev_f32 v83, s52, v83
    v_subrev_f32 v84, s52, v84
    v_subrev_f32 v85, s52, v85
    v_subrev_f32 v86, s52, v86
    v_subrev_f32 v87, s52, v87
    v_mul_f32 v48, v80, v80
    v_mul_f32 v49, v81, v81
    v_fmac_f32 v48, v82, v82
    v_fmac_f32 v49, v83, v83
    v_fmac_f32 v48, v84, v84
    v_fmac_f32 v49, v85, v85
    v_fmac_f32 v48, v86, v86
    v_fmac_f32 v49, v87, v87
    v_add_f32 v48, v48, v49
    s_nop 1
    v_add_f32_dpp v48, v48, v48 row_ror:8 row_mask:0xf bank_mask:0xf
    s_nop 1
    v_add_f32_dpp v48, v48, v48 row_ror:4 row_mask:0xf bank_mask:0xf
    s_nop 1
    v_add_f32_dpp v48, v48, v48 row_ror:2 row_mask:0xf bank_mask:0xf
    s_nop 1
    v_add_f32_dpp v48, v48, v48 row_ror:1 row_mask:0xf bank_mask:0xf
    s_nop 1
    v_add_f32_dpp v48, v48, v48 row_bcast:15 row_mask:0xa bank_mask:0xf
    s_nop 1
    v_add_f32_dpp v48, v48, v48 row_bcast:31 row_mask:0xc bank_mask:0xf
    s_xor_b32 s56, s57, 36864
    buffer_load_dwordx4 v[132:135], v1, s[12:15], s56 offen offset:0 nt
    s_waitcnt lgkmcnt(0)
    v_mul_f32 v48, 0x3b000000, v48
    v_cvt_pk_bf16_f32 v50, s52, s52
    v_readlane_b32 s53, v48, 63
    v_lshlrev_b32 v50, 16, v50
    v_lshlrev_b32 v80, 16, v44
    v_cvt_pk_bf16_f32 v48, s53, s53
    v_and_b32 v81, 0xffff0000, v44
    v_lshlrev_b32 v48, 16, v48
    v_lshlrev_b32 v82, 16, v45
    v_add_f32 v48, 0x3727c5ac, v48
    v_and_b32 v83, 0xffff0000, v45
    v_cvt_pk_bf16_f32 v48, v48, v48
    v_lshlrev_b32 v84, 16, v46
    v_lshlrev_b32 v48, 16, v48
    v_lshlrev_b32 v85, 16, v47
    v_sqrt_f32 v48, v48
    v_sub_f32 v80, v80, v50
    v_sub_f32 v81, v81, v50
    v_sub_f32 v82, v82, v50
    v_sub_f32 v83, v83, v50
    v_sub_f32 v84, v84, v50
    v_sub_f32 v85, v85, v50
    v_cvt_pk_bf16_f32 v48, v48, v48
    v_cvt_pk_bf16_f32 v40, v80, v81
    v_cvt_pk_bf16_f32 v41, v82, v83
    v_cvt_pk_bf16_f32 v42, v84, v85
    v_lshlrev_b32 v48, 16, v48
    v_rcp_f32 v49, v48
    v_lshlrev_b32 v80, 16, v40
    v_and_b32 v81, 0xffff0000, v40
    v_lshlrev_b32 v82, 16, v41
    v_and_b32 v83, 0xffff0000, v41
    v_lshlrev_b32 v84, 16, v42
    v_and_b32 v85, 0xffff0000, v42
    v_mul_f32 v88, v80, v49
    v_mul_f32 v89, v81, v49
    v_mul_f32 v90, v82, v49
    v_mul_f32 v91, v83, v49
    v_mul_f32 v92, v84, v49
    v_mul_f32 v93, v85, v49
    v_fma_f32 v80, -v88, v48, v80
    v_fma_f32 v81, -v89, v48, v81
    v_fma_f32 v82, -v90, v48, v82
    v_fma_f32 v83, -v91, v48, v83
    v_fma_f32 v84, -v92, v48, v84
    v_fma_f32 v85, -v93, v48, v85
    v_fmac_f32 v88, v80, v49
    v_fmac_f32 v89, v81, v49
    v_fmac_f32 v90, v82, v49
    v_fmac_f32 v91, v83, v49
    v_fmac_f32 v92, v84, v49
    v_fmac_f32 v93, v85, v49
    v_cvt_pk_bf16_f32 v40, v88, v88
    v_cvt_pk_bf16_f32 v41, v89, v89
    v_cvt_pk_bf16_f32 v42, v90, v90
    v_cvt_pk_bf16_f32 v43, v91, v91
    v_cvt_pk_bf16_f32 v44, v92, v92
    v_cvt_pk_bf16_f32 v45, v93, v93
    s_xor_b32 s56, s57, 40960
    buffer_load_dwordx4 v[136:139], v1, s[12:15], s56 offen offset:0 nt
    v_and_b32 v16, v40, v4
    v_and_b32 v17, v40, v5
    v_and_b32 v18, v40, v6
    v_and_b32 v19, v40, v7
    v_and_b32 v20, v41, v4
    v_and_b32 v21, v41, v5
    v_and_b32 v22, v41, v6
    v_and_b32 v23, v41, v7
    s_waitcnt vmcnt(7)
    v_mfma_f32_16x16x32_bf16 v[12:15], v[16:19], a[240:243], 0
    v_and_b32 v16, v42, v4
    v_and_b32 v17, v42, v5
    v_and_b32 v18, v42, v6
    v_and_b32 v19, v42, v7
    s_waitcnt vmcnt(6)
    v_mfma_f32_16x16x32_bf16 v[12:15], v[20:23], a[244:247], v[12:15]
    v_and_b32 v20, v43, v4
    v_and_b32 v21, v43, v5
    v_and_b32 v22, v43, v6
    v_and_b32 v23, v43, v7
    s_waitcnt vmcnt(5)
    v_mfma_f32_16x16x32_bf16 v[12:15], v[16:19], a[248:251], v[12:15]
    s_waitcnt vmcnt(4)
    v_mfma_f32_16x16x32_bf16 v[12:15], v[20:23], a[252:255], v[12:15]
    s_lshl_b32 s52, s3, 9
    v_lshlrev_b32 v3, 5, v60
    v_lshl_add_u32 v3, v61, 4, v3
    v_add_u32 v3, s52, v3
    v_and_b32 v40, 0xffff, v44
    v_and_b32 v41, 0xffff0000, v44
    v_and_b32 v42, 0xffff, v45
    v_and_b32 v43, 0xffff0000, v45
    s_mov_b64 exec, 0xffffffff
    ds_write_b128 v3, v[12:15] offset:0
    s_mov_b64 exec, -1
    s_xor_b32 s56, s57, 45056
    buffer_load_dwordx4 v[140:143], v1, s[12:15], s56 offen offset:0 nt
    s_waitcnt lgkmcnt(0)
    s_add_u32 s82, s82, 1
    s_mul_i32 s83, s82, 0x9e3779b1
    v_mov_b32 v56, s83
    s_barrier
    ds_read_b128 v[80:83], v62 offset:0
    ds_read_b128 v[84:87], v62 offset:512
    ds_read_b128 v[88:91], v62 offset:1024
    ds_read_b128 v[92:95], v62 offset:1536
    v_lshrrev_b32 v57, 8, v56
    v_lshrrev_b32 v58, 16, v56
    v_lshrrev_b32 v59, 24, v56
    s_lshl_b32 s52, s62, 9
    s_add_u32 s52, s52, 139264
    s_add_u32 s52, s52, s65
    v_add_u32 v3, s52, v62
    s_waitcnt lgkmcnt(2)
    v_add_f32 v80, v80, v84
    v_add_f32 v81, v81, v85
    v_add_f32 v82, v82, v86
    v_add_f32 v83, v83, v87
    s_waitcnt lgkmcnt(0)
    v_add_f32 v88, v88, v92
    v_add_f32 v89, v89, v93
    v_add_f32 v90, v90, v94
    v_add_f32 v91, v91, v95
    v_add_f32 v80, v80, v88
    v_add_f32 v81, v81, v89
    v_add_f32 v82, v82, v90
    v_add_f32 v83, v83, v91
    v_add_u32 v80, 0x80, v80
    v_add_u32 v81, 0x80, v81
    v_add_u32 v82, 0x80, v82
    v_add_u32 v83, 0x80, v83
    v_bfi_b32 v80, s64, v80, v56
    v_bfi_b32 v81, s64, v81, v57
    v_bfi_b32 v82, s64, v82, v58
    v_bfi_b32 v83, s64, v83, v59
    s_mov_b64 exec, 0xffffffff
    buffer_store_dwordx4 v[80:83], v3, s[40:43], 0 offen sc1
    s_mov_b64 exec, -1
    s_lshl_b32 s52, s4, 12
    s_lshl_b32 s53, s3, 7
    s_add_u32 s52, s52, s53
    s_add_u32 s52, s52, 139264
    v_lshrrev_b32 v2, 3, v0
    v_lshlrev_b32 v2, 9, v2
    v_and_b32 v50, 7, v0
    v_lshl_add_u32 v2, v50, 4, v2
    v_add_u32 v2, s52, v2
    s_lshl_b32 s52, s3, 6
    v_lshl_add_u32 v54, v50, 3, s52
    v_lshlrev_b32 v55, 4, v60
    buffer_load_dwordx4 v[64:67], v63, s[28:31], 0 offen nt
    s_xor_b32 s56, s57, 49152
    buffer_load_dwordx4 v[144:147], v1, s[12:15], s56 offen offset:0 nt
    s_xor_b32 s56, s57, 53248
    buffer_load_dwordx4 v[148:151], v1, s[12:15], s56 offen offset:0 nt
    buffer_load_dwordx4 v[72:75], v63, s[32:35], 0 offen nt
    s_xor_b32 s56, s57, 57344
    buffer_load_dwordx4 v[152:155], v1, s[12:15], s56 offen offset:0 nt
    s_waitcnt vmcnt(10)
    s_xor_b32 s56, s57, 61440
    buffer_load_dwordx4 v[156:159], v1, s[12:15], s56 offen offset:0 nt
    s_waitcnt vmcnt(10)
    buffer_load_dwordx4 v[68:71], v63, s[28:31], s84 offen nt
    s_xor_b32 s56, s57, 65536
    buffer_load_dwordx4 v[160:163], v1, s[12:15], s56 offen offset:0 nt
    s_waitcnt vmcnt(11)
    s_xor_b32 s56, s57, 69632
    buffer_load_dwordx4 v[164:167], v1, s[12:15], s56 offen offset:0 nt
    s_waitcnt vmcnt(11)
    buffer_load_dwordx4 v[76:79], v63, s[32:35], s84 offen nt
    s_xor_b32 s56, s57, 73728
    buffer_load_dwordx4 v[168:171], v1, s[12:15], s56 offen offset:0 nt
    s_waitcnt vmcnt(12)
    s_xor_b32 s56, s57, 77824
    buffer_load_dwordx4 v[172:175], v1, s[12:15], s56 offen offset:0 nt
    s_waitcnt vmcnt(10)
    buffer_load_dwordx4 v[84:87], v2, s[40:43], 0 offen sc1
    s_xor_b32 s56, s57, 81920
    buffer_load_dwordx4 v[176:179], v1, s[12:15], s56 offen offset:0 nt
    s_waitcnt vmcnt(11)
    s_xor_b32 s56, s57, 86016
    buffer_load_dwordx4 v[180:183], v1, s[12:15], s56 offen offset:0 nt
    s_waitcnt vmcnt(10)
    s_xor_b32 s56, s57, 90112
    buffer_load_dwordx4 v[184:187], v1, s[12:15], s56 offen offset:0 nt
    s_waitcnt vmcnt(10)
    s_xor_b32 s56, s57, 94208
    buffer_load_dwordx4 v[188:191], v1, s[12:15], s56 offen offset:0 nt
    s_waitcnt vmcnt(9)
    s_xor_b32 s56, s57, 98304
    buffer_load_dwordx4 v[192:195], v1, s[12:15], s56 offen offset:0 nt
    s_waitcnt vmcnt(9)
    s_xor_b32 s56, s57, 102400
    buffer_load_dwordx4 v[196:199], v1, s[12:15], s56 offen offset:0 nt
    v_dot2_f32_bf16 v16, v64, v40, 0
    v_dot2_f32_bf16 v17, v64, v41, 0
    v_dot2_f32_bf16 v18, v65, v40, 0
    v_dot2_f32_bf16 v19, v65, v41, 0
    v_dot2_f32_bf16 v20, v66, v40, 0
    v_dot2_f32_bf16 v21, v66, v41, 0
    v_dot2_f32_bf16 v22, v67, v40, 0
    v_dot2_f32_bf16 v23, v67, v41, 0
    v_dot2_f32_bf16 v24, v72, v40, 0
    v_dot2_f32_bf16 v25, v72, v41, 0
    v_dot2_f32_bf16 v26, v73, v40, 0
    v_dot2_f32_bf16 v27, v73, v41, 0
    v_dot2_f32_bf16 v28, v74, v40, 0
    v_dot2_f32_bf16 v29, v74, v41, 0
    v_dot2_f32_bf16 v30, v75, v40, 0
    v_dot2_f32_bf16 v31, v75, v41, 0
    s_waitcnt vmcnt(9)
    v_dot2_f32_bf16 v16, v68, v42, v16
    v_dot2_f32_bf16 v17, v68, v43, v17
    v_dot2_f32_bf16 v18, v69, v42, v18
    v_dot2_f32_bf16 v19, v69, v43, v19
    v_dot2_f32_bf16 v20, v70, v42, v20
    v_dot2_f32_bf16 v21, v70, v43, v21
    v_dot2_f32_bf16 v22, v71, v42, v22
    v_dot2_f32_bf16 v23, v71, v43, v23
    v_dot2_f32_bf16 v24, v76, v42, v24
    v_dot2_f32_bf16 v25, v76, v43, v25
    v_dot2_f32_bf16 v26, v77, v42, v26
    v_dot2_f32_bf16 v27, v77, v43, v27
    v_dot2_f32_bf16 v28, v78, v42, v28
    v_dot2_f32_bf16 v29, v78, v43, v29
    v_dot2_f32_bf16 v30, v79, v42, v30
    v_dot2_f32_bf16 v31, v79, v43, v31
    v_and_b32 v3, 3, v0
    v_lshlrev_b32 v3, 6, v3
    v_lshl_add_u32 v3, v61, 2, v3
    s_lshl_b32 s52, s3, 8
    v_add_u32 v3, s52, v3
    v_permlane32_swap_b32 v16, v24
    v_permlane32_swap_b32 v17, v25
    v_permlane32_swap_b32 v18, v26
    v_permlane32_swap_b32 v19, v27
    v_permlane32_swap_b32 v20, v28
    v_permlane32_swap_b32 v21, v29
    v_permlane32_swap_b32 v22, v30
    v_permlane32_swap_b32 v23, v31
    v_add_f32 v16, v16, v24
    v_add_f32 v17, v17, v25
    v_add_f32 v18, v18, v26
    v_add_f32 v19, v19, v27
    v_add_f32 v20, v20, v28
    v_add_f32 v21, v21, v29
    v_add_f32 v22, v22, v30
    v_add_f32 v23, v23, v31
    v_permlane16_swap_b32 v16, v20
    v_permlane16_swap_b32 v17, v21
    v_permlane16_swap_b32 v18, v22
    v_permlane16_swap_b32 v19, v23
    v_add_f32 v16, v16, v20
    v_add_f32 v17, v17, v21
    v_add_f32 v18, v18, v22
    v_add_f32 v19, v19, v23
    v_add_f32_dpp v16, v16, v16 row_ror:4 row_mask:0xf bank_mask:0xf
    v_add_f32_dpp v17, v17, v17 row_ror:4 row_mask:0xf bank_mask:0xf
    v_add_f32_dpp v18, v18, v18 row_ror:4 row_mask:0xf bank_mask:0xf
    v_add_f32_dpp v19, v19, v19 row_ror:4 row_mask:0xf bank_mask:0xf
    v_add_f32_dpp v16, v16, v16 row_ror:8 row_mask:0xf bank_mask:0xf
    v_add_f32_dpp v17, v17, v17 row_ror:8 row_mask:0xf bank_mask:0xf
    v_add_f32_dpp v18, v18, v18 row_ror:8 row_mask:0xf bank_mask:0xf
    v_add_f32_dpp v19, v19, v19 row_ror:8 row_mask:0xf bank_mask:0xf
    s_mov_b32 exec_lo, 0x000f000f
    s_mov_b32 exec_hi, 0x000f000f
    ds_write_b32 v3, v16 offset:2048
    ds_write_b32 v3, v17 offset:2064
    ds_write_b32 v3, v18 offset:2080
    ds_write_b32 v3, v19 offset:2096
    s_mov_b64 exec, -1
    s_waitcnt vmcnt(8)
    s_xor_b32 s56, s57, 106496
    buffer_load_dwordx4 v[200:203], v1, s[12:15], s56 offen offset:0 nt
    s_waitcnt vmcnt(8)
    s_xor_b32 s56, s57, 110592
    buffer_load_dwordx4 v[204:207], v1, s[12:15], s56 offen offset:0 nt
    s_waitcnt vmcnt(8)
L_q_chk:
    v_xor_b32 v3, v84, v56
    v_bitop3_b32 v3, v85, v57, v3 bitop3:0xbe
    v_bitop3_b32 v3, v86, v58, v3 bitop3:0xbe
    v_bitop3_b32 v3, v87, v59, v3 bitop3:0xbe
    v_and_b32 v3, 0xff, v3
    v_cmp_ne_u32 vcc, 0, v3
    s_cbranch_vccz L_q_ok
L_q_re:
    s_sleep 2
    buffer_load_dwordx4 v[84:87], v2, s[40:43], 0 offen sc1
    s_sub_u32 s81, s81, 1
    s_cbranch_scc1 L_end
    s_waitcnt vmcnt(0)
    s_branch L_q_chk
L_q_ok:
    v_and_b32 v84, s64, v84
    v_and_b32 v85, s64, v85
    v_and_b32 v86, s64, v86
    v_and_b32 v87, s64, v87
    s_nop 0
    v_permlane32_swap_b32 v84, v86
    v_permlane32_swap_b32 v85, v87
    v_add_f32 v84, v84, v86
    v_add_f32 v85, v85, v87
    v_mov_b32 v86, v84
    v_mov_b32 v87, v85
    s_nop 0
    v_permlane16_swap_b32 v84, v86
    v_permlane16_swap_b32 v85, v87
    v_add_f32 v84, v84, v86
    v_add_f32 v85, v85, v87
    s_nop 0
    v_add_f32_dpp v84, v84, v84 row_ror:8 row_mask:0xf bank_mask:0xf
    v_add_f32_dpp v85, v85, v85 row_ror:8 row_mask:0xf bank_mask:0xf
    v_lshrrev_b32 v3, 5, v0
    v_lshl_add_u32 v54, v3, 2, v54
    v_cvt_pk_bf16_f32 v84, v84, v85
    s_mov_b32 exec_lo, 0xff
    s_mov_b32 exec_hi, 0xff
    ds_write_b32 v54, v84 offset:3072
    s_mov_b64 exec, -1
    s_xor_b32 s56, s57, 114688
    buffer_load_dwordx4 v[208:211], v1, s[12:15], s56 offen offset:0 nt
    s_waitcnt lgkmcnt(0)
    s_barrier
    ds_read_b128 v[8:11], v55 offset:3072
    ds_read_b128 v[16:19], v62 offset:2048
    ds_read_b128 v[20:23], v62 offset:2304
    ds_read_b128 v[24:27], v62 offset:2560
    ds_read_b128 v[28:31], v62 offset:2816
    s_lshl_b32 s52, s6, 8
    s_add_u32 s52, s52, 270336
    s_or_b32 s53, s59, s65
    s_add_u32 s52, s52, s53
    v_add_u32 v3, s52, v62
    s_waitcnt lgkmcnt(2)
    v_add_f32 v16, v16, v20
    v_add_f32 v17, v17, v21
    v_add_f32 v18, v18, v22
    v_add_f32 v19, v19, v23
    s_waitcnt lgkmcnt(0)
    v_add_f32 v24, v24, v28
    v_add_f32 v25, v25, v29
    v_add_f32 v26, v26, v30
    v_add_f32 v27, v27, v31
    v_add_f32 v16, v16, v24
    v_add_f32 v17, v17, v25
    v_add_f32 v18, v18, v26
    v_add_f32 v19, v19, v27
    v_add_u32 v16, 0x80, v16
    v_add_u32 v17, 0x80, v17
    v_add_u32 v18, 0x80, v18
    v_add_u32 v19, 0x80, v19
    v_bfi_b32 v16, s64, v16, v56
    v_bfi_b32 v17, s64, v17, v57
    v_bfi_b32 v18, s64, v18, v58
    v_bfi_b32 v19, s64, v19, v59
    s_mov_b64 exec, 0xffff
    buffer_store_dwordx4 v[16:19], v3, s[40:43], 0 offen sc1
    s_mov_b64 exec, -1
    s_and_b32 s52, s6, 0xfc
    s_lshl_b32 s52, s52, 8
    s_lshl_b32 s53, s3, 6
    s_add_u32 s52, s52, s53
    s_add_u32 s52, s52, 270336
    s_add_u32 s52, s52, s59
    v_and_b32 v2, 3, v0
    v_lshlrev_b32 v2, 8, v2
    v_lshl_add_u32 v2, v61, 4, v2
    v_add_u32 v2, s52, v2
    s_lshr_b32 s52, s6, 2
    s_lshl_b32 s52, s52, 15
    s_lshl_b32 s53, s3, 13
    s_add_u32 s52, s52, s53
    s_and_b32 s53, s6, 3
    s_lshl_b32 s53, s53, 8
    s_add_u32 s52, s52, s53
    v_lshl_add_u32 v54, v61, 10, v55
    v_add_u32 v54, s52, v54
    s_lshl_b32 s52, s4, 17
    s_lshl_b32 s53, s3, 15
    s_add_u32 s52, s52, s53
    s_lshl_b32 s53, s5, 7
    s_add_u32 s52, s52, s53
    v_lshrrev_b32 v3, 3, v0
    v_lshlrev_b32 v3, 10, v3
    v_and_b32 v50, 7, v0
    v_lshl_add_u32 v3, v50, 4, v3
    v_add_u32 v63, s52, v3
    s_lshl_b32 s55, s3, 12
    s_add_u32 s55, s55, 5632
    v_mov_b32 v40, 0xff800000
    v_dot2_f32_bf16 v80, v96, v8, 0
    v_dot2_f32_bf16 v81, v100, v8, 0
    v_dot2_f32_bf16 v82, v104, v8, 0
    v_dot2_f32_bf16 v83, v108, v8, 0
    v_dot2_f32_bf16 v80, v97, v9, v80
    v_dot2_f32_bf16 v81, v101, v9, v81
    v_dot2_f32_bf16 v82, v105, v9, v82
    v_dot2_f32_bf16 v83, v109, v9, v83
    v_dot2_f32_bf16 v80, v98, v10, v80
    v_dot2_f32_bf16 v81, v102, v10, v81
    v_dot2_f32_bf16 v82, v106, v10, v82
    v_dot2_f32_bf16 v83, v110, v10, v83
    v_dot2_f32_bf16 v80, v99, v11, v80
    v_dot2_f32_bf16 v81, v103, v11, v81
    v_dot2_f32_bf16 v82, v107, v11, v82
    v_dot2_f32_bf16 v83, v111, v11, v83
    v_dot2_f32_bf16 v84, v112, v8, 0
    v_dot2_f32_bf16 v85, v116, v8, 0
    v_dot2_f32_bf16 v86, v120, v8, 0
    v_dot2_f32_bf16 v87, v124, v8, 0
    v_dot2_f32_bf16 v84, v113, v9, v84
    v_dot2_f32_bf16 v85, v117, v9, v85
    v_dot2_f32_bf16 v86, v121, v9, v86
    v_dot2_f32_bf16 v87, v125, v9, v87
    v_dot2_f32_bf16 v84, v114, v10, v84
    v_dot2_f32_bf16 v85, v118, v10, v85
    v_dot2_f32_bf16 v86, v122, v10, v86
    v_dot2_f32_bf16 v87, v126, v10, v87
    v_dot2_f32_bf16 v84, v115, v11, v84
    v_dot2_f32_bf16 v85, v119, v11, v85
    v_dot2_f32_bf16 v86, v123, v11, v86
    v_dot2_f32_bf16 v87, v127, v11, v87
    s_waitcnt vmcnt(8)
    s_xor_b32 s56, s57, 118784
    buffer_load_dwordx4 v[212:215], v1, s[12:15], s56 offen offset:0 nt
    v_dot2_f32_bf16 v88, v128, v8, 0
    v_dot2_f32_bf16 v89, v132, v8, 0
    v_dot2_f32_bf16 v90, v136, v8, 0
    v_dot2_f32_bf16 v91, v140, v8, 0
    v_dot2_f32_bf16 v88, v129, v9, v88
    v_dot2_f32_bf16 v89, v133, v9, v89
    v_dot2_f32_bf16 v90, v137, v9, v90
    v_dot2_f32_bf16 v91, v141, v9, v91
    v_dot2_f32_bf16 v88, v130, v10, v88
    v_dot2_f32_bf16 v89, v134, v10, v89
    v_dot2_f32_bf16 v90, v138, v10, v90
    v_dot2_f32_bf16 v91, v142, v10, v91
    v_dot2_f32_bf16 v88, v131, v11, v88
    v_dot2_f32_bf16 v89, v135, v11, v89
    v_dot2_f32_bf16 v90, v139, v11, v90
    v_dot2_f32_bf16 v91, v143, v11, v91
    v_dot2_f32_bf16 v92, v144, v8, 0
    v_dot2_f32_bf16 v93, v148, v8, 0
    v_dot2_f32_bf16 v94, v152, v8, 0
    v_dot2_f32_bf16 v95, v156, v8, 0
    v_dot2_f32_bf16 v92, v145, v9, v92
    v_dot2_f32_bf16 v93, v149, v9, v93
    v_dot2_f32_bf16 v94, v153, v9, v94
    v_dot2_f32_bf16 v95, v157, v9, v95
    v_dot2_f32_bf16 v92, v146, v10, v92
    v_dot2_f32_bf16 v93, v150, v10, v93
    v_dot2_f32_bf16 v94, v154, v10, v94
    v_dot2_f32_bf16 v95, v158, v10, v95
    v_dot2_f32_bf16 v92, v147, v11, v92
    v_dot2_f32_bf16 v93, v151, v11, v93
    v_dot2_f32_bf16 v94, v155, v11, v94
    v_dot2_f32_bf16 v95, v159, v11, v95
    s_waitcnt vmcnt(8)
    s_xor_b32 s56, s57, 122880
    buffer_load_dwordx4 v[216:219], v1, s[12:15], s56 offen offset:0 nt
    v_add_f32_dpp v80, v80, v80 row_ror:8 row_mask:0xf bank_mask:0x3
    v_add_f32_dpp v81, v81, v81 row_ror:8 row_mask:0xf bank_mask:0x3
    v_add_f32_dpp v82, v82, v82 row_ror:8 row_mask:0xf bank_mask:0x3
    v_add_f32_dpp v83, v83, v83 row_ror:8 row_mask:0xf bank_mask:0x3
    v_add_f32_dpp v84, v84, v84 row_ror:8 row_mask:0xf bank_mask:0x3
    v_add_f32_dpp v85, v85, v85 row_ror:8 row_mask:0xf bank_mask:0x3
    v_add_f32_dpp v86, v86, v86 row_ror:8 row_mask:0xf bank_mask:0x3
    v_add_f32_dpp v87, v87, v87 row_ror:8 row_mask:0xf bank_mask:0x3
    v_add_f32_dpp v80, v88, v88 row_ror:8 row_mask:0xf bank_mask:0xc
    v_add_f32_dpp v81, v89, v89 row_ror:8 row_mask:0xf bank_mask:0xc
    v_add_f32_dpp v82, v90, v90 row_ror:8 row_mask:0xf bank_mask:0xc
    v_add_f32_dpp v83, v91, v91 row_ror:8 row_mask:0xf bank_mask:0xc
    v_add_f32_dpp v84, v92, v92 row_ror:8 row_mask:0xf bank_mask:0xc
    v_add_f32_dpp v85, v93, v93 row_ror:8 row_mask:0xf bank_mask:0xc
    v_add_f32_dpp v86, v94, v94 row_ror:8 row_mask:0xf bank_mask:0xc
    v_add_f32_dpp v87, v95, v95 row_ror:8 row_mask:0xf bank_mask:0xc
    v_add_f32_dpp v80, v80, v80 row_half_mirror row_mask:0xf bank_mask:0x5
    v_add_f32_dpp v81, v81, v81 row_half_mirror row_mask:0xf bank_mask:0x5
    v_add_f32_dpp v82, v82, v82 row_half_mirror row_mask:0xf bank_mask:0x5
    v_add_f32_dpp v83, v83, v83 row_half_mirror row_mask:0xf bank_mask:0x5
    v_add_f32_dpp v80, v84, v84 row_half_mirror row_mask:0xf bank_mask:0xa
    v_add_f32_dpp v81, v85, v85 row_half_mirror row_mask:0xf bank_mask:0xa
    v_add_f32_dpp v82, v86, v86 row_half_mirror row_mask:0xf bank_mask:0xa
    v_add_f32_dpp v83, v87, v87 row_half_mirror row_mask:0xf bank_mask:0xa
    v_add_f32_dpp v80, v80, v80 quad_perm:[1,0,3,2] row_mask:0xf bank_mask:0xf
    v_add_f32_dpp v81, v81, v81 quad_perm:[1,0,3,2] row_mask:0xf bank_mask:0xf
    v_add_f32_dpp v82, v82, v82 quad_perm:[1,0,3,2] row_mask:0xf bank_mask:0xf
    v_add_f32_dpp v83, v83, v83 quad_perm:[1,0,3,2] row_mask:0xf bank_mask:0xf
    v_add_f32_dpp v64, v80, v80 quad_perm:[2,3,0,1] row_mask:0xf bank_mask:0xf
    v_add_f32_dpp v65, v81, v81 quad_perm:[2,3,0,1] row_mask:0xf bank_mask:0xf
    v_add_f32_dpp v66, v82, v82 quad_perm:[2,3,0,1] row_mask:0xf bank_mask:0xf
    v_add_f32_dpp v67, v83, v83 quad_perm:[2,3,0,1] row_mask:0xf bank_mask:0xf
    v_cvt_pk_bf16_f32 v65, v64, v65
    v_cvt_pk_bf16_f32 v67, v66, v67
    v_lshlrev_b32 v64, 16, v65
    v_lshlrev_b32 v66, 16, v67
    v_and_b32 v65, 0xffff0000, v65
    v_and_b32 v67, 0xffff0000, v67
    v_mul_f32 v64, 0x3db504f3, v64
    v_mul_f32 v65, 0x3db504f3, v65
    v_mul_f32 v66, 0x3db504f3, v66
    v_mul_f32 v67, 0x3db504f3, v67
    v_cvt_pk_bf16_f32 v65, v64, v65
    v_cvt_pk_bf16_f32 v67, v66, v67
    v_lshlrev_b32 v64, 16, v65
    v_lshlrev_b32 v66, 16, v67
    v_and_b32 v65, 0xffff0000, v65
    v_and_b32 v67, 0xffff0000, v67
    v_max3_f32 v40, v64, v65, v40
    v_max3_f32 v40, v66, v67, v40
    v_dot2_f32_bf16 v80, v160, v8, 0
    v_dot2_f32_bf16 v81, v164, v8, 0
    v_dot2_f32_bf16 v82, v168, v8, 0
    v_dot2_f32_bf16 v83, v172, v8, 0
    v_dot2_f32_bf16 v80, v161, v9, v80
    v_dot2_f32_bf16 v81, v165, v9, v81
    v_dot2_f32_bf16 v82, v169, v9, v82
    v_dot2_f32_bf16 v83, v173, v9, v83
    v_dot2_f32_bf16 v80, v162, v10, v80
    v_dot2_f32_bf16 v81, v166, v10, v81
    v_dot2_f32_bf16 v82, v170, v10, v82
    v_dot2_f32_bf16 v83, v174, v10, v83
    v_dot2_f32_bf16 v80, v163, v11, v80
    v_dot2_f32_bf16 v81, v167, v11, v81
    v_dot2_f32_bf16 v82, v171, v11, v82
    v_dot2_f32_bf16 v83, v175, v11, v83
    v_dot2_f32_bf16 v84, v176, v8, 0
    v_dot2_f32_bf16 v84, v177, v9, v84
    v_dot2_f32_bf16 v84, v178, v10, v84
    v_dot2_f32_bf16 v84, v179, v11, v84
    v_dot2_f32_bf16 v85, v180, v8, 0
    v_dot2_f32_bf16 v85, v181, v9, v85
    v_dot2_f32_bf16 v85, v182, v10, v85
    v_dot2_f32_bf16 v85, v183, v11, v85
    v_dot2_f32_bf16 v86, v184, v8, 0
    v_dot2_f32_bf16 v86, v185, v9, v86
    v_dot2_f32_bf16 v86, v186, v10, v86
    v_dot2_f32_bf16 v86, v187, v11, v86
    s_waitcnt vmcnt(8)
    v_dot2_f32_bf16 v87, v188, v8, 0
    v_dot2_f32_bf16 v87, v189, v9, v87
    v_dot2_f32_bf16 v87, v190, v10, v87
    v_dot2_f32_bf16 v87, v191, v11, v87
    s_xor_b32 s56, s57, 126976
    buffer_load_dwordx4 v[220:223], v1, s[12:15], s56 offen offset:0 nt
    s_waitcnt vmcnt(8)
    v_dot2_f32_bf16 v88, v192, v8, 0
    v_dot2_f32_bf16 v88, v193, v9, v88
    v_dot2_f32_bf16 v88, v194, v10, v88
    v_dot2_f32_bf16 v88, v195, v11, v88
    s_xor_b32 s56, s57, 131072
    buffer_load_dwordx4 v[224:227], v1, s[12:15], s56 offen offset:0 nt
    s_waitcnt vmcnt(8)
    v_dot2_f32_bf16 v89, v196, v8, 0
    v_dot2_f32_bf16 v89, v197, v9, v89
    v_dot2_f32_bf16 v89, v198, v10, v89
    v_dot2_f32_bf16 v89, v199, v11, v89
    s_xor_b32 s56, s57, 135168
    buffer_load_dwordx4 v[228:231], v1, s[12:15], s56 offen offset:0 nt
    s_waitcnt vmcnt(8)
    v_dot2_f32_bf16 v90, v200, v8, 0
    v_dot2_f32_bf16 v90, v201, v9, v90
    v_dot2_f32_bf16 v90, v202, v10, v90
    v_dot2_f32_bf16 v90, v203, v11, v90
    s_xor_b32 s56, s57, 139264
    buffer_load_dwordx4 v[232:235], v1, s[12:15], s56 offen offset:0 nt
    s_waitcnt vmcnt(8)
    v_dot2_f32_bf16 v91, v204, v8, 0
    v_dot2_f32_bf16 v91, v205, v9, v91
    v_dot2_f32_bf16 v91, v206, v10, v91
    v_dot2_f32_bf16 v91, v207, v11, v91
    s_xor_b32 s56, s57, 143360
    buffer_load_dwordx4 v[236:239], v1, s[12:15], s56 offen offset:0 nt
    s_waitcnt vmcnt(8)
    v_dot2_f32_bf16 v92, v208, v8, 0
    v_dot2_f32_bf16 v92, v209, v9, v92
    v_dot2_f32_bf16 v92, v210, v10, v92
    v_dot2_f32_bf16 v92, v211, v11, v92
    s_xor_b32 s56, s57, 147456
    buffer_load_dwordx4 v[240:243], v1, s[12:15], s56 offen offset:0 nt
    s_waitcnt vmcnt(7)
    v_dot2_f32_bf16 v93, v212, v8, 0
    v_dot2_f32_bf16 v93, v213, v9, v93
    v_dot2_f32_bf16 v93, v214, v10, v93
    v_dot2_f32_bf16 v93, v215, v11, v93
    s_xor_b32 s56, s57, 151552
    buffer_load_dwordx4 v[244:247], v1, s[12:15], s56 offen offset:0 nt
    s_waitcnt vmcnt(7)
    v_dot2_f32_bf16 v94, v216, v8, 0
    v_dot2_f32_bf16 v94, v217, v9, v94
    v_dot2_f32_bf16 v94, v218, v10, v94
    v_dot2_f32_bf16 v94, v219, v11, v94
    s_xor_b32 s56, s57, 155648
    buffer_load_dwordx4 v[248:251], v1, s[12:15], s56 offen offset:0 nt
    s_waitcnt vmcnt(7)
    v_dot2_f32_bf16 v95, v220, v8, 0
    v_dot2_f32_bf16 v95, v221, v9, v95
    v_dot2_f32_bf16 v95, v222, v10, v95
    v_dot2_f32_bf16 v95, v223, v11, v95
    s_xor_b32 s56, s57, 159744
    buffer_load_dwordx4 v[252:255], v1, s[12:15], s56 offen offset:0 nt
    v_add_f32_dpp v80, v80, v80 row_ror:8 row_mask:0xf bank_mask:0x3
    v_add_f32_dpp v81, v81, v81 row_ror:8 row_mask:0xf bank_mask:0x3
    v_add_f32_dpp v82, v82, v82 row_ror:8 row_mask:0xf bank_mask:0x3
    v_add_f32_dpp v83, v83, v83 row_ror:8 row_mask:0xf bank_mask:0x3
    v_add_f32_dpp v84, v84, v84 row_ror:8 row_mask:0xf bank_mask:0x3
    v_add_f32_dpp v85, v85, v85 row_ror:8 row_mask:0xf bank_mask:0x3
    v_add_f32_dpp v86, v86, v86 row_ror:8 row_mask:0xf bank_mask:0x3
    v_add_f32_dpp v87, v87, v87 row_ror:8 row_mask:0xf bank_mask:0x3
    v_add_f32_dpp v80, v88, v88 row_ror:8 row_mask:0xf bank_mask:0xc
    v_add_f32_dpp v81, v89, v89 row_ror:8 row_mask:0xf bank_mask:0xc
    v_add_f32_dpp v82, v90, v90 row_ror:8 row_mask:0xf bank_mask:0xc
    v_add_f32_dpp v83, v91, v91 row_ror:8 row_mask:0xf bank_mask:0xc
    v_add_f32_dpp v84, v92, v92 row_ror:8 row_mask:0xf bank_mask:0xc
    v_add_f32_dpp v85, v93, v93 row_ror:8 row_mask:0xf bank_mask:0xc
    v_add_f32_dpp v86, v94, v94 row_ror:8 row_mask:0xf bank_mask:0xc
    v_add_f32_dpp v87, v95, v95 row_ror:8 row_mask:0xf bank_mask:0xc
    v_add_f32_dpp v80, v80, v80 row_half_mirror row_mask:0xf bank_mask:0x5
    v_add_f32_dpp v81, v81, v81 row_half_mirror row_mask:0xf bank_mask:0x5
    v_add_f32_dpp v82, v82, v82 row_half_mirror row_mask:0xf bank_mask:0x5
    v_add_f32_dpp v83, v83, v83 row_half_mirror row_mask:0xf bank_mask:0x5
    v_add_f32_dpp v80, v84, v84 row_half_mirror row_mask:0xf bank_mask:0xa
    v_add_f32_dpp v81, v85, v85 row_half_mirror row_mask:0xf bank_mask:0xa
    v_add_f32_dpp v82, v86, v86 row_half_mirror row_mask:0xf bank_mask:0xa
    v_add_f32_dpp v83, v87, v87 row_half_mirror row_mask:0xf bank_mask:0xa
    v_add_f32_dpp v80, v80, v80 quad_perm:[1,0,3,2] row_mask:0xf bank_mask:0xf
    v_add_f32_dpp v81, v81, v81 quad_perm:[1,0,3,2] row_mask:0xf bank_mask:0xf
    v_add_f32_dpp v82, v82, v82 quad_perm:[1,0,3,2] row_mask:0xf bank_mask:0xf
    v_add_f32_dpp v83, v83, v83 quad_perm:[1,0,3,2] row_mask:0xf bank_mask:0xf
    v_add_f32_dpp v68, v80, v80 quad_perm:[2,3,0,1] row_mask:0xf bank_mask:0xf
    v_add_f32_dpp v69, v81, v81 quad_perm:[2,3,0,1] row_mask:0xf bank_mask:0xf
    v_add_f32_dpp v70, v82, v82 quad_perm:[2,3,0,1] row_mask:0xf bank_mask:0xf
    v_add_f32_dpp v71, v83, v83 quad_perm:[2,3,0,1] row_mask:0xf bank_mask:0xf
    v_cvt_pk_bf16_f32 v69, v68, v69
    v_cvt_pk_bf16_f32 v71, v70, v71
    v_lshlrev_b32 v68, 16, v69
    v_lshlrev_b32 v70, 16, v71
    v_and_b32 v69, 0xffff0000, v69
    v_and_b32 v71, 0xffff0000, v71
    v_mul_f32 v68, 0x3db504f3, v68
    v_mul_f32 v69, 0x3db504f3, v69
    v_mul_f32 v70, 0x3db504f3, v70
    v_mul_f32 v71, 0x3db504f3, v71
    v_cvt_pk_bf16_f32 v69, v68, v69
    v_cvt_pk_bf16_f32 v71, v70, v71
    v_lshlrev_b32 v68, 16, v69
    v_lshlrev_b32 v70, 16, v71
    v_and_b32 v69, 0xffff0000, v69
    v_and_b32 v71, 0xffff0000, v71
    v_max3_f32 v40, v68, v69, v40
    v_max3_f32 v40, v70, v71, v40
    s_waitcnt vmcnt(7)
    v_dot2_f32_bf16 v80, v224, v8, 0
    v_dot2_f32_bf16 v80, v225, v9, v80
    v_dot2_f32_bf16 v80, v226, v10, v80
    v_dot2_f32_bf16 v80, v227, v11, v80
    s_xor_b32 s56, s57, 163840
    buffer_load_dwordx4 v[96:99], v1, s[12:15], s56 offen offset:0 nt
    s_waitcnt vmcnt(7)
    v_dot2_f32_bf16 v81, v228, v8, 0
    v_dot2_f32_bf16 v81, v229, v9, v81
    v_dot2_f32_bf16 v81, v230, v10, v81
    v_dot2_f32_bf16 v81, v231, v11, v81
    s_xor_b32 s56, s57, 167936
    buffer_load_dwordx4 v[100:103], v1, s[12:15], s56 offen offset:0 nt
    s_waitcnt vmcnt(7)
    v_dot2_f32_bf16 v82, v232, v8, 0
    v_dot2_f32_bf16 v82, v233, v9, v82
    v_dot2_f32_bf16 v82, v234, v10, v82
    v_dot2_f32_bf16 v82, v235, v11, v82
    s_xor_b32 s56, s57, 172032
    buffer_load_dwordx4 v[104:107], v1, s[12:15], s56 offen offset:0 nt
    s_waitcnt vmcnt(7)
    v_dot2_f32_bf16 v83, v236, v8, 0
    v_dot2_f32_bf16 v83, v237, v9, v83
    v_dot2_f32_bf16 v83, v238, v10, v83
    v_dot2_f32_bf16 v83, v239, v11, v83
    s_xor_b32 s56, s57, 176128
    buffer_load_dwordx4 v[108:111], v1, s[12:15], s56 offen offset:0 nt
    s_movk_i32 s53, 4096
    buffer_load_dwordx4 v[48:51], v2, s[40:43], 0 offen sc1
    buffer_load_dwordx4 a[232:235], v54, s[36:39], 0 offen nt
    buffer_load_dwordx4 a[236:239], v54, s[36:39], s53 offen nt
    s_waitcnt vmcnt(10)
    v_dot2_f32_bf16 v84, v240, v8, 0
    v_dot2_f32_bf16 v84, v241, v9, v84
    v_dot2_f32_bf16 v84, v242, v10, v84
    v_dot2_f32_bf16 v84, v243, v11, v84
    s_xor_b32 s56, s57, 180224
    buffer_load_dwordx4 v[112:115], v1, s[12:15], s56 offen offset:0 nt
    s_waitcnt vmcnt(10)
    v_dot2_f32_bf16 v85, v244, v8, 0
    v_dot2_f32_bf16 v85, v245, v9, v85
    v_dot2_f32_bf16 v85, v246, v10, v85
    v_dot2_f32_bf16 v85, v247, v11, v85
    s_xor_b32 s56, s57, 184320
    buffer_load_dwordx4 v[116:119], v1, s[12:15], s56 offen offset:0 nt
    s_waitcnt vmcnt(10)
    v_dot2_f32_bf16 v86, v248, v8, 0
    v_dot2_f32_bf16 v86, v249, v9, v86
    v_dot2_f32_bf16 v86, v250, v10, v86
    v_dot2_f32_bf16 v86, v251, v11, v86
    s_xor_b32 s56, s57, 188416
    buffer_load_dwordx4 v[120:123], v1, s[12:15], s56 offen offset:0 nt
    s_waitcnt vmcnt(10)
    v_dot2_f32_bf16 v87, v252, v8, 0
    v_dot2_f32_bf16 v87, v253, v9, v87
    v_dot2_f32_bf16 v87, v254, v10, v87
    v_dot2_f32_bf16 v87, v255, v11, v87
    s_xor_b32 s56, s57, 192512
    buffer_load_dwordx4 v[124:127], v1, s[12:15], s56 offen offset:0 nt
    s_waitcnt vmcnt(10)
    v_dot2_f32_bf16 v88, v96, v8, 0
    v_dot2_f32_bf16 v88, v97, v9, v88
    v_dot2_f32_bf16 v88, v98, v10, v88
    v_dot2_f32_bf16 v88, v99, v11, v88
    s_xor_b32 s56, s57, 196608
    buffer_load_dwordx4 v[128:131], v1, s[12:15], s56 offen offset:0 nt
    s_waitcnt vmcnt(10)
    v_dot2_f32_bf16 v89, v100, v8, 0
    v_dot2_f32_bf16 v89, v101, v9, v89
    v_dot2_f32_bf16 v89, v102, v10, v89
    v_dot2_f32_bf16 v89, v103, v11, v89
    s_xor_b32 s56, s57, 200704
    buffer_load_dwordx4 v[132:135], v1, s[12:15], s56 offen offset:0 nt
    s_waitcnt vmcnt(10)
    v_dot2_f32_bf16 v90, v104, v8, 0
    v_dot2_f32_bf16 v90, v105, v9, v90
    v_dot2_f32_bf16 v90, v106, v10, v90
    v_dot2_f32_bf16 v90, v107, v11, v90
    s_xor_b32 s56, s57, 204800
    buffer_load_dwordx4 v[136:139], v1, s[12:15], s56 offen offset:0 nt
    s_waitcnt vmcnt(10)
    v_dot2_f32_bf16 v91, v108, v8, 0
    v_dot2_f32_bf16 v91, v109, v9, v91
    v_dot2_f32_bf16 v91, v110, v10, v91
    v_dot2_f32_bf16 v91, v111, v11, v91
    s_xor_b32 s56, s57, 208896
    buffer_load_dwordx4 v[140:143], v1, s[12:15], s56 offen offset:0 nt
    s_waitcnt vmcnt(8)
    s_cmp_eq_u32 s59, 0
    s_cbranch_scc0 L_gp_ok
L_gp_chk:
    v_xor_b32 v3, v48, v56
    v_bitop3_b32 v3, v49, v57, v3 bitop3:0xbe
    v_bitop3_b32 v3, v50, v58, v3 bitop3:0xbe
    v_bitop3_b32 v3, v51, v59, v3 bitop3:0xbe
    v_and_b32 v3, 0xff, v3
    v_cmp_ne_u32 vcc, 0, v3
    s_cbranch_vccz L_gp_ok
L_gp_re:
    s_sleep 2
    buffer_load_dwordx4 v[48:51], v2, s[40:43], 0 offen sc1
    s_sub_u32 s81, s81, 1
    s_cbranch_scc1 L_end
    s_waitcnt vmcnt(0)
    s_branch L_gp_chk
L_gp_ok:
    v_and_b32 v48, s64, v48
    v_and_b32 v49, s64, v49
    v_and_b32 v50, s64, v50
    v_and_b32 v51, s64, v51
    v_add_f32_dpp v48, v48, v48 quad_perm:[1,0,3,2] row_mask:0xf bank_mask:0xf
    v_add_f32_dpp v49, v49, v49 quad_perm:[1,0,3,2] row_mask:0xf bank_mask:0xf
    v_add_f32_dpp v50, v50, v50 quad_perm:[1,0,3,2] row_mask:0xf bank_mask:0xf
    v_add_f32_dpp v51, v51, v51 quad_perm:[1,0,3,2] row_mask:0xf bank_mask:0xf
    v_add_f32_dpp v48, v48, v48 quad_perm:[2,3,0,1] row_mask:0xf bank_mask:0xf
    v_add_f32_dpp v49, v49, v49 quad_perm:[2,3,0,1] row_mask:0xf bank_mask:0xf
    v_add_f32_dpp v50, v50, v50 quad_perm:[2,3,0,1] row_mask:0xf bank_mask:0xf
    v_add_f32_dpp v51, v51, v51 quad_perm:[2,3,0,1] row_mask:0xf bank_mask:0xf
    v_cvt_pk_bf16_f32 v48, v48, v49
    v_cvt_pk_bf16_f32 v50, v50, v51
    v_and_b32 v49, 0xffff0000, v48
    v_lshlrev_b32 v48, 16, v48
    v_and_b32 v51, 0xffff0000, v50
    v_lshlrev_b32 v50, 16, v50
    v_mul_f32 v48, s61, v48
    v_mul_f32 v49, s61, v49
    v_exp_f32 v48, v48
    v_exp_f32 v49, v49
    v_add_f32 v48, 1.0, v48
    v_add_f32 v49, 1.0, v49
    v_rcp_f32 v48, v48
    v_rcp_f32 v49, v49
    s_nop 0
    v_cvt_pk_bf16_f32 v48, v48, v49
    v_and_b32 v49, 0xffff0000, v48
    v_lshlrev_b32 v48, 16, v48
    v_mul_f32 v48, v48, v50
    v_mul_f32 v49, v49, v51
    v_cvt_pk_bf16_f32 v48, v48, v48
    v_cvt_pk_bf16_f32 v49, v49, v49
    v_and_b32 v16, v48, v4
    v_and_b32 v17, v48, v5
    v_and_b32 v18, v48, v6
    v_and_b32 v19, v48, v7
    v_and_b32 v20, v49, v4
    v_and_b32 v21, v49, v5
    v_and_b32 v22, v49, v6
    v_and_b32 v23, v49, v7
    v_mfma_f32_16x16x32_bf16 v[12:15], v[16:19], a[232:235], 0
    s_nop 0
    v_mfma_f32_16x16x32_bf16 v[12:15], v[20:23], a[236:239], v[12:15]
    s_lshl_b32 s52, s3, 9
    v_lshlrev_b32 v3, 5, v60
    v_lshl_add_u32 v3, v61, 4, v3
    v_add_u32 v3, s52, v3
    s_mov_b64 exec, 0xffffffff
    s_nop 2
    ds_write_b128 v3, v[12:15] offset:0
    s_mov_b64 exec, -1
    s_waitcnt vmcnt(7)
    v_dot2_f32_bf16 v92, v112, v8, 0
    v_dot2_f32_bf16 v92, v113, v9, v92
    v_dot2_f32_bf16 v92, v114, v10, v92
    v_dot2_f32_bf16 v92, v115, v11, v92
    s_xor_b32 s56, s57, 212992
    buffer_load_dwordx4 v[144:147], v1, s[12:15], s56 offen offset:0 nt
    s_waitcnt vmcnt(7)
    v_dot2_f32_bf16 v93, v116, v8, 0
    v_dot2_f32_bf16 v93, v117, v9, v93
    v_dot2_f32_bf16 v93, v118, v10, v93
    v_dot2_f32_bf16 v93, v119, v11, v93
    s_xor_b32 s56, s57, 217088
    buffer_load_dwordx4 v[148:151], v1, s[12:15], s56 offen offset:0 nt
    s_waitcnt vmcnt(7)
    v_dot2_f32_bf16 v94, v120, v8, 0
    v_dot2_f32_bf16 v94, v121, v9, v94
    v_dot2_f32_bf16 v94, v122, v10, v94
    v_dot2_f32_bf16 v94, v123, v11, v94
    s_xor_b32 s56, s57, 221184
    buffer_load_dwordx4 v[152:155], v1, s[12:15], s56 offen offset:0 nt
    s_waitcnt vmcnt(7)
    v_dot2_f32_bf16 v95, v124, v8, 0
    v_dot2_f32_bf16 v95, v125, v9, v95
    v_dot2_f32_bf16 v95, v126, v10, v95
    v_dot2_f32_bf16 v95, v127, v11, v95
    s_xor_b32 s56, s57, 225280
    buffer_load_dwordx4 v[156:159], v1, s[12:15], s56 offen offset:0 nt
    v_add_f32_dpp v80, v80, v80 row_ror:8 row_mask:0xf bank_mask:0x3
    v_add_f32_dpp v81, v81, v81 row_ror:8 row_mask:0xf bank_mask:0x3
    v_add_f32_dpp v82, v82, v82 row_ror:8 row_mask:0xf bank_mask:0x3
    v_add_f32_dpp v83, v83, v83 row_ror:8 row_mask:0xf bank_mask:0x3
    v_add_f32_dpp v84, v84, v84 row_ror:8 row_mask:0xf bank_mask:0x3
    v_add_f32_dpp v85, v85, v85 row_ror:8 row_mask:0xf bank_mask:0x3
    v_add_f32_dpp v86, v86, v86 row_ror:8 row_mask:0xf bank_mask:0x3
    v_add_f32_dpp v87, v87, v87 row_ror:8 row_mask:0xf bank_mask:0x3
    v_add_f32_dpp v80, v88, v88 row_ror:8 row_mask:0xf bank_mask:0xc
    v_add_f32_dpp v81, v89, v89 row_ror:8 row_mask:0xf bank_mask:0xc
    v_add_f32_dpp v82, v90, v90 row_ror:8 row_mask:0xf bank_mask:0xc
    v_add_f32_dpp v83, v91, v91 row_ror:8 row_mask:0xf bank_mask:0xc
    v_add_f32_dpp v84, v92, v92 row_ror:8 row_mask:0xf bank_mask:0xc
    v_add_f32_dpp v85, v93, v93 row_ror:8 row_mask:0xf bank_mask:0xc
    v_add_f32_dpp v86, v94, v94 row_ror:8 row_mask:0xf bank_mask:0xc
    v_add_f32_dpp v87, v95, v95 row_ror:8 row_mask:0xf bank_mask:0xc
    v_add_f32_dpp v80, v80, v80 row_half_mirror row_mask:0xf bank_mask:0x5
    v_add_f32_dpp v81, v81, v81 row_half_mirror row_mask:0xf bank_mask:0x5
    v_add_f32_dpp v82, v82, v82 row_half_mirror row_mask:0xf bank_mask:0x5
    v_add_f32_dpp v83, v83, v83 row_half_mirror row_mask:0xf bank_mask:0x5
    v_add_f32_dpp v80, v84, v84 row_half_mirror row_mask:0xf bank_mask:0xa
    v_add_f32_dpp v81, v85, v85 row_half_mirror row_mask:0xf bank_mask:0xa
    v_add_f32_dpp v82, v86, v86 row_half_mirror row_mask:0xf bank_mask:0xa
    v_add_f32_dpp v83, v87, v87 row_half_mirror row_mask:0xf bank_mask:0xa
    v_add_f32_dpp v80, v80, v80 quad_perm:[1,0,3,2] row_mask:0xf bank_mask:0xf
    v_add_f32_dpp v81, v81, v81 quad_perm:[1,0,3,2] row_mask:0xf bank_mask:0xf
    v_add_f32_dpp v82, v82, v82 quad_perm:[1,0,3,2] row_mask:0xf bank_mask:0xf
    v_add_f32_dpp v83, v83, v83 quad_perm:[1,0,3,2] row_mask:0xf bank_mask:0xf
    v_add_f32_dpp v72, v80, v80 quad_perm:[2,3,0,1] row_mask:0xf bank_mask:0xf
    v_add_f32_dpp v73, v81, v81 quad_perm:[2,3,0,1] row_mask:0xf bank_mask:0xf
    v_add_f32_dpp v74, v82, v82 quad_perm:[2,3,0,1] row_mask:0xf bank_mask:0xf
    v_add_f32_dpp v75, v83, v83 quad_perm:[2,3,0,1] row_mask:0xf bank_mask:0xf
    v_cvt_pk_bf16_f32 v73, v72, v73
    v_cvt_pk_bf16_f32 v75, v74, v75
    v_lshlrev_b32 v72, 16, v73
    v_lshlrev_b32 v74, 16, v75
    v_and_b32 v73, 0xffff0000, v73
    v_and_b32 v75, 0xffff0000, v75
    v_mul_f32 v72, 0x3db504f3, v72
    v_mul_f32 v73, 0x3db504f3, v73
    v_mul_f32 v74, 0x3db504f3, v74
    v_mul_f32 v75, 0x3db504f3, v75
    v_cvt_pk_bf16_f32 v73, v72, v73
    v_cvt_pk_bf16_f32 v75, v74, v75
    v_lshlrev_b32 v72, 16, v73
    v_lshlrev_b32 v74, 16, v75
    v_and_b32 v73, 0xffff0000, v73
    v_and_b32 v75, 0xffff0000, v75
    v_max3_f32 v40, v72, v73, v40
    v_max3_f32 v40, v74, v75, v40
    s_waitcnt vmcnt(7)
    v_dot2_f32_bf16 v80, v128, v8, 0
    v_dot2_f32_bf16 v80, v129, v9, v80
    v_dot2_f32_bf16 v80, v130, v10, v80
    v_dot2_f32_bf16 v80, v131, v11, v80
    s_xor_b32 s56, s57, 229376
    buffer_load_dwordx4 v[160:163], v1, s[12:15], s56 offen offset:0 nt
    s_waitcnt vmcnt(7)
    v_dot2_f32_bf16 v81, v132, v8, 0
    v_dot2_f32_bf16 v81, v133, v9, v81
    v_dot2_f32_bf16 v81, v134, v10, v81
    v_dot2_f32_bf16 v81, v135, v11, v81
    s_xor_b32 s56, s57, 233472
    buffer_load_dwordx4 v[164:167], v1, s[12:15], s56 offen offset:0 nt
    s_waitcnt vmcnt(7)
    v_dot2_f32_bf16 v82, v136, v8, 0
    v_dot2_f32_bf16 v82, v137, v9, v82
    v_dot2_f32_bf16 v82, v138, v10, v82
    v_dot2_f32_bf16 v82, v139, v11, v82
    s_xor_b32 s56, s57, 237568
    buffer_load_dwordx4 v[168:171], v1, s[12:15], s56 offen offset:0 nt
    s_waitcnt vmcnt(7)
    v_dot2_f32_bf16 v83, v140, v8, 0
    v_dot2_f32_bf16 v83, v141, v9, v83
    v_dot2_f32_bf16 v83, v142, v10, v83
    v_dot2_f32_bf16 v83, v143, v11, v83
    s_xor_b32 s56, s57, 241664
    buffer_load_dwordx4 v[172:175], v1, s[12:15], s56 offen offset:0 nt
    s_waitcnt vmcnt(7)
    v_dot2_f32_bf16 v84, v144, v8, 0
    v_dot2_f32_bf16 v84, v145, v9, v84
    v_dot2_f32_bf16 v84, v146, v10, v84
    v_dot2_f32_bf16 v84, v147, v11, v84
    s_xor_b32 s56, s57, 245760
    buffer_load_dwordx4 v[176:179], v1, s[12:15], s56 offen offset:0 nt
    s_waitcnt vmcnt(7)
    v_dot2_f32_bf16 v85, v148, v8, 0
    v_dot2_f32_bf16 v85, v149, v9, v85
    v_dot2_f32_bf16 v85, v150, v10, v85
    v_dot2_f32_bf16 v85, v151, v11, v85
    s_xor_b32 s56, s57, 249856
    buffer_load_dwordx4 v[180:183], v1, s[12:15], s56 offen offset:0 nt
    s_waitcnt vmcnt(7)
    v_dot2_f32_bf16 v86, v152, v8, 0
    v_dot2_f32_bf16 v86, v153, v9, v86
    v_dot2_f32_bf16 v86, v154, v10, v86
    v_dot2_f32_bf16 v86, v155, v11, v86
    s_xor_b32 s56, s57, 253952
    buffer_load_dwordx4 v[184:187], v1, s[12:15], s56 offen offset:0 nt
    s_waitcnt vmcnt(7)
    v_dot2_f32_bf16 v87, v156, v8, 0
    v_dot2_f32_bf16 v87, v157, v9, v87
    v_dot2_f32_bf16 v87, v158, v10, v87
    v_dot2_f32_bf16 v87, v159, v11, v87
    s_xor_b32 s56, s57, 258048
    buffer_load_dwordx4 v[188:191], v1, s[12:15], s56 offen offset:0 nt
    s_waitcnt vmcnt(7)
    v_dot2_f32_bf16 v88, v160, v8, 0
    v_dot2_f32_bf16 v88, v161, v9, v88
    v_dot2_f32_bf16 v88, v162, v10, v88
    v_dot2_f32_bf16 v88, v163, v11, v88
    buffer_load_dwordx4 a[0:3], v1, s[20:23], s57 offen offset:0 nt
    s_waitcnt vmcnt(7)
    v_dot2_f32_bf16 v89, v164, v8, 0
    v_dot2_f32_bf16 v89, v165, v9, v89
    v_dot2_f32_bf16 v89, v166, v10, v89
    v_dot2_f32_bf16 v89, v167, v11, v89
    s_xor_b32 s58, s57, 4096
    buffer_load_dwordx4 a[4:7], v1, s[20:23], s58 offen offset:0 nt
    s_waitcnt vmcnt(7)
    v_dot2_f32_bf16 v90, v168, v8, 0
    v_dot2_f32_bf16 v90, v169, v9, v90
    v_dot2_f32_bf16 v90, v170, v10, v90
    v_dot2_f32_bf16 v90, v171, v11, v90
    s_xor_b32 s58, s57, 8192
    buffer_load_dwordx4 a[8:11], v1, s[20:23], s58 offen offset:0 nt
    s_waitcnt vmcnt(7)
    v_dot2_f32_bf16 v91, v172, v8, 0
    v_dot2_f32_bf16 v91, v173, v9, v91
    v_dot2_f32_bf16 v91, v174, v10, v91
    v_dot2_f32_bf16 v91, v175, v11, v91
    s_xor_b32 s58, s57, 12288
    buffer_load_dwordx4 a[12:15], v1, s[20:23], s58 offen offset:0 nt
    s_waitcnt vmcnt(7)
    v_dot2_f32_bf16 v92, v176, v8, 0
    v_dot2_f32_bf16 v92, v177, v9, v92
    v_dot2_f32_bf16 v92, v178, v10, v92
    v_dot2_f32_bf16 v92, v179, v11, v92
    s_xor_b32 s58, s57, 16384
    buffer_load_dwordx4 a[16:19], v1, s[20:23], s58 offen offset:0 nt
    s_waitcnt vmcnt(7)
    v_dot2_f32_bf16 v93, v180, v8, 0
    v_dot2_f32_bf16 v93, v181, v9, v93
    v_dot2_f32_bf16 v93, v182, v10, v93
    v_dot2_f32_bf16 v93, v183, v11, v93
    s_xor_b32 s58, s57, 20480
    buffer_load_dwordx4 a[20:23], v1, s[20:23], s58 offen offset:0 nt
    s_waitcnt vmcnt(7)
    v_dot2_f32_bf16 v94, v184, v8, 0
    v_dot2_f32_bf16 v94, v185, v9, v94
    v_dot2_f32_bf16 v94, v186, v10, v94
    v_dot2_f32_bf16 v94, v187, v11, v94
    s_xor_b32 s58, s57, 24576
    buffer_load_dwordx4 a[24:27], v1, s[20:23], s58 offen offset:0 nt
    s_waitcnt vmcnt(7)
    v_dot2_f32_bf16 v95, v188, v8, 0
    v_dot2_f32_bf16 v95, v189, v9, v95
    v_dot2_f32_bf16 v95, v190, v10, v95
    v_dot2_f32_bf16 v95, v191, v11, v95
    s_xor_b32 s58, s57, 28672
    buffer_load_dwordx4 a[28:31], v1, s[20:23], s58 offen offset:0 nt
    v_add_f32_dpp v80, v80, v80 row_ror:8 row_mask:0xf bank_mask:0x3
    v_add_f32_dpp v81, v81, v81 row_ror:8 row_mask:0xf bank_mask:0x3
    v_add_f32_dpp v82, v82, v82 row_ror:8 row_mask:0xf bank_mask:0x3
    v_add_f32_dpp v83, v83, v83 row_ror:8 row_mask:0xf bank_mask:0x3
    v_add_f32_dpp v84, v84, v84 row_ror:8 row_mask:0xf bank_mask:0x3
    v_add_f32_dpp v85, v85, v85 row_ror:8 row_mask:0xf bank_mask:0x3
    v_add_f32_dpp v86, v86, v86 row_ror:8 row_mask:0xf bank_mask:0x3
    v_add_f32_dpp v87, v87, v87 row_ror:8 row_mask:0xf bank_mask:0x3
    v_add_f32_dpp v80, v88, v88 row_ror:8 row_mask:0xf bank_mask:0xc
    v_add_f32_dpp v81, v89, v89 row_ror:8 row_mask:0xf bank_mask:0xc
    v_add_f32_dpp v82, v90, v90 row_ror:8 row_mask:0xf bank_mask:0xc
    v_add_f32_dpp v83, v91, v91 row_ror:8 row_mask:0xf bank_mask:0xc
    v_add_f32_dpp v84, v92, v92 row_ror:8 row_mask:0xf bank_mask:0xc
    v_add_f32_dpp v85, v93, v93 row_ror:8 row_mask:0xf bank_mask:0xc
    v_add_f32_dpp v86, v94, v94 row_ror:8 row_mask:0xf bank_mask:0xc
    v_add_f32_dpp v87, v95, v95 row_ror:8 row_mask:0xf bank_mask:0xc
    v_add_f32_dpp v80, v80, v80 row_half_mirror row_mask:0xf bank_mask:0x5
    v_add_f32_dpp v81, v81, v81 row_half_mirror row_mask:0xf bank_mask:0x5
    v_add_f32_dpp v82, v82, v82 row_half_mirror row_mask:0xf bank_mask:0x5
    v_add_f32_dpp v83, v83, v83 row_half_mirror row_mask:0xf bank_mask:0x5
    v_add_f32_dpp v80, v84, v84 row_half_mirror row_mask:0xf bank_mask:0xa
    v_add_f32_dpp v81, v85, v85 row_half_mirror row_mask:0xf bank_mask:0xa
    v_add_f32_dpp v82, v86, v86 row_half_mirror row_mask:0xf bank_mask:0xa
    v_add_f32_dpp v83, v87, v87 row_half_mirror row_mask:0xf bank_mask:0xa
    v_add_f32_dpp v80, v80, v80 quad_perm:[1,0,3,2] row_mask:0xf bank_mask:0xf
    v_add_f32_dpp v81, v81, v81 quad_perm:[1,0,3,2] row_mask:0xf bank_mask:0xf
    v_add_f32_dpp v82, v82, v82 quad_perm:[1,0,3,2] row_mask:0xf bank_mask:0xf
    v_add_f32_dpp v83, v83, v83 quad_perm:[1,0,3,2] row_mask:0xf bank_mask:0xf
    v_add_f32_dpp v76, v80, v80 quad_perm:[2,3,0,1] row_mask:0xf bank_mask:0xf
    v_add_f32_dpp v77, v81, v81 quad_perm:[2,3,0,1] row_mask:0xf bank_mask:0xf
    v_add_f32_dpp v78, v82, v82 quad_perm:[2,3,0,1] row_mask:0xf bank_mask:0xf
    v_add_f32_dpp v79, v83, v83 quad_perm:[2,3,0,1] row_mask:0xf bank_mask:0xf
    v_cvt_pk_bf16_f32 v77, v76, v77
    v_cvt_pk_bf16_f32 v79, v78, v79
    v_lshlrev_b32 v76, 16, v77
    v_lshlrev_b32 v78, 16, v79
    v_and_b32 v77, 0xffff0000, v77
    v_and_b32 v79, 0xffff0000, v79
    v_mul_f32 v76, 0x3db504f3, v76
    v_mul_f32 v77, 0x3db504f3, v77
    v_mul_f32 v78, 0x3db504f3, v78
    v_mul_f32 v79, 0x3db504f3, v79
    v_cvt_pk_bf16_f32 v77, v76, v77
    v_cvt_pk_bf16_f32 v79, v78, v79
    v_lshlrev_b32 v76, 16, v77
    v_lshlrev_b32 v78, 16, v79
    v_and_b32 v77, 0xffff0000, v77
    v_and_b32 v79, 0xffff0000, v79
    v_max3_f32 v40, v76, v77, v40
    v_max3_f32 v40, v78, v79, v40
    s_nop 1
    v_max_f32_dpp v40, v40, v40 row_ror:4 row_mask:0xf bank_mask:0xf
    s_lshl_b32 s52, s3, 2
    v_mov_b32 v3, s52
    v_max_f32_dpp v40, v40, v40 row_ror:8 row_mask:0xf bank_mask:0xf
    v_mov_b32 v48, 0
    v_mov_b32 v41, v40
    s_nop 1
    v_permlane16_swap_b32 v41, v40
    v_max_f32 v40, v40, v41
    v_mov_b32 v41, v40
    s_nop 1
    v_permlane32_swap_b32 v41, v40
    v_max_f32 v40, v40, v41
    s_mov_b64 exec, 1
    ds_write_b32 v3, v40 offset:3328
    s_mov_b64 exec, -1
    s_xor_b32 s58, s57, 32768
    buffer_load_dwordx4 a[32:35], v1, s[20:23], s58 offen offset:0 nt
    s_waitcnt lgkmcnt(0)
    s_barrier
    ds_read_b128 v[44:47], v48 offset:3328
    ds_read_b128 v[96:99], v62 offset:0
    ds_read_b128 v[100:103], v62 offset:512
    ds_read_b128 v[104:107], v62 offset:1024
    ds_read_b128 v[108:111], v62 offset:1536
    v_lshlrev_b32 v49, 3, v61
    v_bfe_u32 v50, v0, 2, 2
    v_add_u32 v49, v49, v50
    v_lshlrev_b32 v49, 7, v49
    v_and_b32 v50, 3, v0
    v_lshl_add_u32 v49, v50, 3, v49
    s_lshl_b32 s52, s3, 5
    v_add_u32 v83, s52, v49
    v_mov_b32 v82, v63
    s_waitcnt lgkmcnt(4)
    v_max3_f32 v40, v44, v45, v46
    v_max_f32 v40, v40, v47
    v_mul_f32 v55, s60, v40
    v_sub_f32 v41, 0, v55
    s_lshl_b32 s52, s6, 9
    s_add_u32 s52, s52, 393216
    s_or_b32 s53, s59, s65
    s_add_u32 s52, s52, s53
    v_add_u32 v89, s52, v62
    s_waitcnt lgkmcnt(0)
    v_add_f32 v96, v96, v100
    v_add_f32 v104, v104, v108
    v_add_f32 v97, v97, v101
    v_add_f32 v105, v105, v109
    v_add_f32 v98, v98, v102
    v_add_f32 v106, v106, v110
    v_add_f32 v99, v99, v103
    v_add_f32 v107, v107, v111
    v_add_f32 v96, v96, v104
    v_add_f32 v97, v97, v105
    v_add_f32 v98, v98, v106
    v_add_f32 v99, v99, v107
    v_add_u32 v96, 0x80, v96
    v_add_u32 v97, 0x80, v97
    v_add_u32 v98, 0x80, v98
    v_add_u32 v99, 0x80, v99
    v_bfi_b32 v96, s64, v96, v56
    v_bfi_b32 v97, s64, v97, v57
    v_bfi_b32 v98, s64, v98, v58
    v_bfi_b32 v99, s64, v99, v59
    s_mov_b64 exec, 0xffffffff
    buffer_store_dwordx4 v[96:99], v89, s[40:43], 0 offen sc1
    s_mov_b64 exec, -1
    v_fma_f32 v64, v64, s60, v41
    v_fma_f32 v65, v65, s60, v41
    v_fma_f32 v66, v66, s60, v41
    v_fma_f32 v67, v67, s60, v41
    v_fma_f32 v68, v68, s60, v41
    v_fma_f32 v69, v69, s60, v41
    v_fma_f32 v70, v70, s60, v41
    v_fma_f32 v71, v71, s60, v41
    v_fma_f32 v72, v72, s60, v41
    v_fma_f32 v73, v73, s60, v41
    v_fma_f32 v74, v74, s60, v41
    v_fma_f32 v75, v75, s60, v41
    v_fma_f32 v76, v76, s60, v41
    v_fma_f32 v77, v77, s60, v41
    v_fma_f32 v78, v78, s60, v41
    v_fma_f32 v79, v79, s60, v41
    s_xor_b32 s58, s57, 36864
    buffer_load_dwordx4 a[36:39], v1, s[20:23], s58 offen offset:0 nt
    v_exp_f32 v64, v64
    v_exp_f32 v65, v65
    v_exp_f32 v66, v66
    v_exp_f32 v67, v67
    v_exp_f32 v68, v68
    v_exp_f32 v69, v69
    v_exp_f32 v70, v70
    v_exp_f32 v71, v71
    v_exp_f32 v72, v72
    v_exp_f32 v73, v73
    v_exp_f32 v74, v74
    v_exp_f32 v75, v75
    v_exp_f32 v76, v76
    v_exp_f32 v77, v77
    v_exp_f32 v78, v78
    v_exp_f32 v79, v79
    v_add_f32 v42, v64, v65
    v_add_f32 v43, v66, v67
    v_add_f32 v42, v42, v68
    v_add_f32 v43, v43, v69
    v_add_f32 v42, v42, v70
    v_add_f32 v43, v43, v71
    v_add_f32 v42, v42, v72
    v_add_f32 v43, v43, v73
    v_add_f32 v42, v42, v74
    v_add_f32 v43, v43, v75
    v_add_f32 v42, v42, v76
    v_add_f32 v43, v43, v77
    v_add_f32 v42, v42, v78
    v_add_f32 v43, v43, v79
    v_add_f32 v42, v42, v43
    s_nop 1
    v_add_f32_dpp v42, v42, v42 row_ror:4 row_mask:0xf bank_mask:0xf
    s_nop 1
    v_add_f32_dpp v42, v42, v42 row_ror:8 row_mask:0xf bank_mask:0xf
    v_mov_b32 v43, v42
    s_nop 1
    v_permlane16_swap_b32 v43, v42
    v_add_f32 v42, v42, v43
    v_mov_b32 v43, v42
    s_nop 1
    v_permlane32_swap_b32 v43, v42
    v_add_f32 v42, v42, v43
    s_mov_b64 exec, 1
    ds_write_b32 v3, v42 offset:3344
    s_mov_b64 exec, -1
    s_waitcnt lgkmcnt(0)
    s_barrier
    ds_read_b128 v[44:47], v48 offset:3344
    s_lshl_b32 s52, s62, 4
    s_add_u32 s52, s52, 491520
    s_add_u32 s52, s52, s65
    v_mov_b32 v3, s52
    s_waitcnt lgkmcnt(0)
    v_add_f32 v44, v44, v45
    v_add_f32 v46, v46, v47
    v_add_f32 v45, v44, v46
    s_mov_b32 s52, 0x04000c0c
    v_perm_b32 v46, v45, v55, s52
    v_and_b32 v47, 0xff, v58
    s_getreg_b32 s52, hwreg(HW_REG_XCC_ID, 0, 4)
    s_lshl_b32 s74, s52, 8
    v_bfi_b32 v44, s64, v55, v56
    v_bfi_b32 v45, s64, v45, v57
    v_or3_b32 v46, v46, s74, v47
    v_mov_b32 v47, v59
    s_mov_b64 exec, 1
    buffer_store_dwordx4 v[44:47], v3, s[40:43], 0 offen sc1
    s_mov_b64 exec, -1
    s_xor_b32 s58, s57, 40960
    buffer_load_dwordx4 a[40:43], v1, s[20:23], s58 offen offset:0 nt
    s_lshl_b32 s52, s3, 9
    v_lshlrev_b32 v51, 5, v60
    v_lshl_add_u32 v51, v61, 4, v51
    v_add_u32 v51, s52, v51
    s_lshl_b32 s52, s62, 9
    s_add_u32 s52, s52, s65
    v_add_u32 v49, s52, v62
    s_lshl_b32 s52, s4, 12
    v_add_u32 v84, s52, v62
    v_lshrrev_b32 v85, 5, v0
    v_lshlrev_b32 v85, 2, v85
    v_and_b32 v3, 31, v0
    v_lshl_add_u32 v85, v3, 3, v85
    v_lshlrev_b32 v86, 4, v61
    v_lshl_add_u32 v53, v61, 4, s63
    s_lshl_b32 s52, s75, 11
    s_add_u32 s52, s52, 327680
    v_add_u32 v52, s52, v62
    s_lshl_b32 s52, s4, 7
    s_add_u32 s52, s52, 491520
    v_and_b32 v2, 7, v0
    v_lshl_add_u32 v2, v2, 4, s52
    s_lshl_b32 s52, s75, 5
    s_add_u32 s52, s52, s80
    v_and_b32 v3, 3, v0
    v_lshlrev_b32 v63, 3, v3
    v_lshl_add_u32 v63, v61, 1, v63
    v_add_u32 v63, s52, v63
    s_lshl_b32 s52, s75, 6
    s_add_u32 s52, s52, 393216
    s_add_u32 s52, s52, s80
    v_lshrrev_b32 v80, 2, v0
    v_lshlrev_b32 v80, 11, v80
    v_lshl_add_u32 v80, v3, 4, v80
    v_add_u32 v80, s52, v80
    v_mov_b32 v3, 0x80000000
    v_cmp_gt_u32 vcc, 44, v0
    s_mov_b32 s66, 0x8000
    s_mov_b32 s67, 0x10000
    v_cndmask_b32 v81, v3, v80, vcc
    s_waitcnt vmcnt(12)
    s_waitcnt vmcnt(11)
    s_waitcnt vmcnt(10)
    s_waitcnt vmcnt(9)
    s_xor_b32 s58, s57, 45056
    buffer_load_dwordx4 a[44:47], v1, s[20:23], s58 offen offset:0 nt
    s_waitcnt vmcnt(9)
    s_xor_b32 s58, s57, 49152
    buffer_load_dwordx4 a[48:51], v1, s[20:23], s58 offen offset:0 nt
    s_waitcnt vmcnt(9)
    s_xor_b32 s58, s57, 53248
    buffer_load_dwordx4 a[52:55], v1, s[20:23], s58 offen offset:0 nt
    s_waitcnt vmcnt(9)
    s_xor_b32 s58, s57, 57344
    buffer_load_dwordx4 a[56:59], v1, s[20:23], s58 offen offset:0 nt
    s_waitcnt vmcnt(9)
    s_xor_b32 s58, s57, 61440
    buffer_load_dwordx4 a[60:63], v1, s[20:23], s58 offen offset:0 nt
    s_waitcnt vmcnt(9)
    s_xor_b32 s58, s57, 65536
    buffer_load_dwordx4 a[64:67], v1, s[20:23], s58 offen offset:0 nt
    s_waitcnt vmcnt(8)
    s_xor_b32 s58, s57, 69632
    buffer_load_dwordx4 a[68:71], v1, s[20:23], s58 offen offset:0 nt
    s_waitcnt vmcnt(7)
    s_xor_b32 s58, s57, 73728
    buffer_load_dwordx4 a[72:75], v1, s[20:23], s58 offen offset:0 nt
    s_waitcnt vmcnt(7)
    s_xor_b32 s58, s57, 77824
    buffer_load_dwordx4 a[76:79], v1, s[20:23], s58 offen offset:0 nt
    s_waitcnt vmcnt(7)
    s_xor_b32 s58, s57, 81920
    buffer_load_dwordx4 a[80:83], v1, s[20:23], s58 offen offset:0 nt
    s_waitcnt vmcnt(7)
    s_xor_b32 s58, s57, 86016
    buffer_load_dwordx4 a[84:87], v1, s[20:23], s58 offen offset:0 nt
    s_waitcnt vmcnt(7)
    s_xor_b32 s58, s57, 90112
    buffer_load_dwordx4 a[88:91], v1, s[20:23], s58 offen offset:0 nt
    s_waitcnt vmcnt(7)
    s_xor_b32 s58, s57, 94208
    buffer_load_dwordx4 a[92:95], v1, s[20:23], s58 offen offset:0 nt
    s_waitcnt vmcnt(7)
    s_xor_b32 s58, s57, 98304
    buffer_load_dwordx4 a[96:99], v1, s[20:23], s58 offen offset:0 nt
    s_waitcnt vmcnt(7)
    s_xor_b32 s58, s57, 102400
    buffer_load_dwordx4 a[100:103], v1, s[20:23], s58 offen offset:0 nt
    s_waitcnt vmcnt(7)
    s_xor_b32 s58, s57, 106496
    buffer_load_dwordx4 a[104:107], v1, s[20:23], s58 offen offset:0 nt
    s_waitcnt vmcnt(7)
    s_xor_b32 s58, s57, 110592
    buffer_load_dwordx4 a[108:111], v1, s[20:23], s58 offen offset:0 nt
    s_waitcnt vmcnt(7)
    s_xor_b32 s58, s57, 114688
    buffer_load_dwordx4 a[112:115], v1, s[20:23], s58 offen offset:0 nt
    s_waitcnt vmcnt(7)
    s_xor_b32 s58, s57, 118784
    buffer_load_dwordx4 a[116:119], v1, s[20:23], s58 offen offset:0 nt
    s_waitcnt vmcnt(7)
    s_xor_b32 s58, s57, 122880
    buffer_load_dwordx4 a[120:123], v1, s[20:23], s58 offen offset:0 nt
    s_waitcnt vmcnt(7)
    s_xor_b32 s58, s57, 126976
    buffer_load_dwordx4 a[124:127], v1, s[20:23], s58 offen offset:0 nt
    s_waitcnt vmcnt(7)
    s_xor_b32 s58, s57, 131072
    buffer_load_dwordx4 a[128:131], v1, s[20:23], s58 offen offset:0 nt
    s_waitcnt vmcnt(7)
    s_xor_b32 s58, s57, 135168
    buffer_load_dwordx4 a[132:135], v1, s[20:23], s58 offen offset:0 nt
    s_waitcnt vmcnt(7)
    s_xor_b32 s58, s57, 139264
    buffer_load_dwordx4 a[136:139], v1, s[20:23], s58 offen offset:0 nt
    s_waitcnt vmcnt(7)
    s_xor_b32 s58, s57, 143360
    buffer_load_dwordx4 a[140:143], v1, s[20:23], s58 offen offset:0 nt
    s_waitcnt vmcnt(7)
    s_xor_b32 s58, s57, 147456
    buffer_load_dwordx4 a[144:147], v1, s[20:23], s58 offen offset:0 nt
    s_waitcnt vmcnt(7)
    s_xor_b32 s58, s57, 151552
    buffer_load_dwordx4 a[148:151], v1, s[20:23], s58 offen offset:0 nt
    s_waitcnt vmcnt(7)
    s_xor_b32 s58, s57, 155648
    buffer_load_dwordx4 a[152:155], v1, s[20:23], s58 offen offset:0 nt
    s_waitcnt vmcnt(7)
    s_xor_b32 s58, s57, 159744
    buffer_load_dwordx4 a[156:159], v1, s[20:23], s58 offen offset:0 nt
    s_waitcnt vmcnt(7)
    buffer_load_dwordx4 v[96:99], v2, s[40:43], 0 offen sc1
    s_xor_b32 s58, s57, 163840
    buffer_load_dwordx4 a[160:163], v1, s[20:23], s58 offen offset:0 nt
    s_waitcnt vmcnt(8)
    s_xor_b32 s58, s57, 167936
    buffer_load_dwordx4 a[164:167], v1, s[20:23], s58 offen offset:0 nt
    s_waitcnt vmcnt(8)
    s_xor_b32 s58, s57, 172032
    buffer_load_dwordx4 a[168:171], v1, s[20:23], s58 offen offset:0 nt
    s_waitcnt vmcnt(8)
    s_xor_b32 s58, s57, 176128
    buffer_load_dwordx4 a[172:175], v1, s[20:23], s58 offen offset:0 nt
    s_waitcnt vmcnt(8)
    s_xor_b32 s58, s57, 180224
    buffer_load_dwordx4 a[176:179], v1, s[20:23], s58 offen offset:0 nt
    s_waitcnt vmcnt(8)
    s_xor_b32 s58, s57, 184320
    buffer_load_dwordx4 a[180:183], v1, s[20:23], s58 offen offset:0 nt
    s_waitcnt vmcnt(8)
    s_xor_b32 s58, s57, 188416
    buffer_load_dwordx4 a[184:187], v1, s[20:23], s58 offen offset:0 nt
    s_waitcnt vmcnt(8)
    s_xor_b32 s58, s57, 192512
    buffer_load_dwordx4 a[188:191], v1, s[20:23], s58 offen offset:0 nt
    s_waitcnt vmcnt(7)
    s_xor_b32 s58, s57, 196608
    buffer_load_dwordx4 a[192:195], v1, s[20:23], s58 offen offset:0 nt
L_ml_chk:
    v_xor_b32 v3, v96, v56
    v_bitop3_b32 v3, v97, v57, v3 bitop3:0xbe
    v_bitop3_b32 v3, v98, v58, v3 bitop3:0xbe
    v_bitop3_b32 v3, v99, v59, v3 bitop3:0xbe
    v_and_b32 v3, 0xff, v3
    v_cmp_ne_u32 vcc, 0, v3
    s_cbranch_vccz L_ml_ok
L_ml_re:
    s_sleep 2
    buffer_load_dwordx4 v[96:99], v2, s[40:43], 0 offen sc1
    s_sub_u32 s81, s81, 1
    s_cbranch_scc1 L_end
    s_waitcnt vmcnt(0)
    s_branch L_ml_chk
L_ml_ok:
    v_and_b32 v96, s64, v96
    v_and_b32 v97, s64, v97
    v_and_b32 v98, s64, v98
    v_and_b32 v99, s64, v99
    v_bfe_u32 v44, v98, 16, 8
    v_lshrrev_b32 v45, 24, v98
    v_and_b32 v98, 0xff00, v98
    v_or_b32 v96, v96, v44
    v_or_b32 v97, v97, v45
    v_cmp_ne_u32 s[76:77], s74, v98
    v_max_f32_dpp v44, v96, v96 row_half_mirror row_mask:0xf bank_mask:0xf
    s_nop 1
    v_max_f32_dpp v44, v44, v44 quad_perm:[2,3,0,1] row_mask:0xf bank_mask:0xf
    s_nop 1
    v_max_f32_dpp v44, v44, v44 quad_perm:[1,0,3,2] row_mask:0xf bank_mask:0xf
    v_sub_f32 v45, v96, v44
    v_sub_f32 v46, v55, v44
    v_exp_f32 v45, v45
    v_exp_f32 v46, v46
    v_mul_f32 v45, v45, v97
    s_nop 1
    v_add_f32_dpp v45, v45, v45 row_half_mirror row_mask:0xf bank_mask:0xf
    s_nop 1
    v_add_f32_dpp v45, v45, v45 quad_perm:[2,3,0,1] row_mask:0xf bank_mask:0xf
    s_nop 1
    v_add_f32_dpp v45, v45, v45 quad_perm:[1,0,3,2] row_mask:0xf bank_mask:0xf
    v_rcp_f32 v44, v45
    s_nop 0
    v_fma_f32 v47, -v45, v44, 1.0
    v_fmac_f32 v44, v47, v44
    v_mul_f32 v45, v44, v46
    s_xor_b32 s58, s57, 200704
    buffer_load_dwordx4 a[196:199], v1, s[20:23], s58 offen offset:0 nt
    v_mul_f32 v64, v64, v45
    v_mul_f32 v65, v65, v45
    v_mul_f32 v66, v66, v45
    v_mul_f32 v67, v67, v45
    v_mul_f32 v68, v68, v45
    v_mul_f32 v69, v69, v45
    v_mul_f32 v70, v70, v45
    v_mul_f32 v71, v71, v45
    v_mul_f32 v72, v72, v45
    v_mul_f32 v73, v73, v45
    v_mul_f32 v74, v74, v45
    v_mul_f32 v75, v75, v45
    v_mul_f32 v76, v76, v45
    v_mul_f32 v77, v77, v45
    v_mul_f32 v78, v78, v45
    v_mul_f32 v79, v79, v45
    v_cvt_pk_bf16_f32 v64, v64, v64
    v_cvt_pk_bf16_f32 v65, v65, v65
    v_cvt_pk_bf16_f32 v66, v66, v66
    v_cvt_pk_bf16_f32 v67, v67, v67
    v_cvt_pk_bf16_f32 v68, v68, v68
    v_cvt_pk_bf16_f32 v69, v69, v69
    v_cvt_pk_bf16_f32 v70, v70, v70
    v_cvt_pk_bf16_f32 v71, v71, v71
    v_cvt_pk_bf16_f32 v72, v72, v72
    v_cvt_pk_bf16_f32 v73, v73, v73
    v_cvt_pk_bf16_f32 v74, v74, v74
    v_cvt_pk_bf16_f32 v75, v75, v75
    v_cvt_pk_bf16_f32 v76, v76, v76
    v_cvt_pk_bf16_f32 v77, v77, v77
    v_cvt_pk_bf16_f32 v78, v78, v78
    v_cvt_pk_bf16_f32 v79, v79, v79
    v_and_b32_dpp v16, v64, v4 row_newbcast:0 row_mask:0xf bank_mask:0xf
    v_and_b32_dpp v17, v64, v5 row_newbcast:0 row_mask:0xf bank_mask:0xf
    v_and_b32_dpp v18, v64, v6 row_newbcast:0 row_mask:0xf bank_mask:0xf
    v_and_b32_dpp v19, v64, v7 row_newbcast:0 row_mask:0xf bank_mask:0xf
    v_and_b32_dpp v20, v65, v4 row_newbcast:0 row_mask:0xf bank_mask:0xf
    v_and_b32_dpp v21, v65, v5 row_newbcast:0 row_mask:0xf bank_mask:0xf
    v_and_b32_dpp v22, v65, v6 row_newbcast:0 row_mask:0xf bank_mask:0xf
    v_and_b32_dpp v23, v65, v7 row_newbcast:0 row_mask:0xf bank_mask:0xf
    v_mfma_f32_16x16x32_bf16 v[12:15], v[16:19], a[0:3], 0
    v_and_b32_dpp v16, v66, v4 row_newbcast:0 row_mask:0xf bank_mask:0xf
    v_and_b32_dpp v17, v66, v5 row_newbcast:0 row_mask:0xf bank_mask:0xf
    v_and_b32_dpp v18, v66, v6 row_newbcast:0 row_mask:0xf bank_mask:0xf
    v_and_b32_dpp v19, v66, v7 row_newbcast:0 row_mask:0xf bank_mask:0xf
    v_mfma_f32_16x16x32_bf16 v[12:15], v[20:23], a[4:7], v[12:15]
    v_and_b32_dpp v20, v67, v4 row_newbcast:0 row_mask:0xf bank_mask:0xf
    v_and_b32_dpp v21, v67, v5 row_newbcast:0 row_mask:0xf bank_mask:0xf
    v_and_b32_dpp v22, v67, v6 row_newbcast:0 row_mask:0xf bank_mask:0xf
    v_and_b32_dpp v23, v67, v7 row_newbcast:0 row_mask:0xf bank_mask:0xf
    v_mfma_f32_16x16x32_bf16 v[12:15], v[16:19], a[8:11], v[12:15]
    v_and_b32_dpp v16, v64, v4 row_newbcast:4 row_mask:0xf bank_mask:0xf
    v_and_b32_dpp v17, v64, v5 row_newbcast:4 row_mask:0xf bank_mask:0xf
    v_and_b32_dpp v18, v64, v6 row_newbcast:4 row_mask:0xf bank_mask:0xf
    v_and_b32_dpp v19, v64, v7 row_newbcast:4 row_mask:0xf bank_mask:0xf
    v_mfma_f32_16x16x32_bf16 v[12:15], v[20:23], a[12:15], v[12:15]
    v_and_b32_dpp v20, v65, v4 row_newbcast:4 row_mask:0xf bank_mask:0xf
    v_and_b32_dpp v21, v65, v5 row_newbcast:4 row_mask:0xf bank_mask:0xf
    v_and_b32_dpp v22, v65, v6 row_newbcast:4 row_mask:0xf bank_mask:0xf
    v_and_b32_dpp v23, v65, v7 row_newbcast:4 row_mask:0xf bank_mask:0xf
    v_mfma_f32_16x16x32_bf16 v[12:15], v[16:19], a[16:19], v[12:15]
    v_and_b32_dpp v16, v66, v4 row_newbcast:4 row_mask:0xf bank_mask:0xf
    v_and_b32_dpp v17, v66, v5 row_newbcast:4 row_mask:0xf bank_mask:0xf
    v_and_b32_dpp v18, v66, v6 row_newbcast:4 row_mask:0xf bank_mask:0xf
    v_and_b32_dpp v19, v66, v7 row_newbcast:4 row_mask:0xf bank_mask:0xf
    v_mfma_f32_16x16x32_bf16 v[12:15], v[20:23], a[20:23], v[12:15]
    s_waitcnt vmcnt(7)
    s_xor_b32 s58, s57, 204800
    buffer_load_dwordx4 a[200:203], v1, s[20:23], s58 offen offset:0 nt
    v_and_b32_dpp v20, v67, v4 row_newbcast:4 row_mask:0xf bank_mask:0xf
    v_and_b32_dpp v21, v67, v5 row_newbcast:4 row_mask:0xf bank_mask:0xf
    v_and_b32_dpp v22, v67, v6 row_newbcast:4 row_mask:0xf bank_mask:0xf
    v_and_b32_dpp v23, v67, v7 row_newbcast:4 row_mask:0xf bank_mask:0xf
    v_mfma_f32_16x16x32_bf16 v[12:15], v[16:19], a[24:27], v[12:15]
    v_and_b32_dpp v16, v64, v4 row_newbcast:8 row_mask:0xf bank_mask:0xf
    v_and_b32_dpp v17, v64, v5 row_newbcast:8 row_mask:0xf bank_mask:0xf
    v_and_b32_dpp v18, v64, v6 row_newbcast:8 row_mask:0xf bank_mask:0xf
    v_and_b32_dpp v19, v64, v7 row_newbcast:8 row_mask:0xf bank_mask:0xf
    v_mfma_f32_16x16x32_bf16 v[12:15], v[20:23], a[28:31], v[12:15]
    v_and_b32_dpp v20, v65, v4 row_newbcast:8 row_mask:0xf bank_mask:0xf
    v_and_b32_dpp v21, v65, v5 row_newbcast:8 row_mask:0xf bank_mask:0xf
    v_and_b32_dpp v22, v65, v6 row_newbcast:8 row_mask:0xf bank_mask:0xf
    v_and_b32_dpp v23, v65, v7 row_newbcast:8 row_mask:0xf bank_mask:0xf
    v_mfma_f32_16x16x32_bf16 v[12:15], v[16:19], a[32:35], v[12:15]
    v_and_b32_dpp v16, v66, v4 row_newbcast:8 row_mask:0xf bank_mask:0xf
    v_and_b32_dpp v17, v66, v5 row_newbcast:8 row_mask:0xf bank_mask:0xf
    v_and_b32_dpp v18, v66, v6 row_newbcast:8 row_mask:0xf bank_mask:0xf
    v_and_b32_dpp v19, v66, v7 row_newbcast:8 row_mask:0xf bank_mask:0xf
    v_mfma_f32_16x16x32_bf16 v[12:15], v[20:23], a[36:39], v[12:15]
    v_and_b32_dpp v20, v67, v4 row_newbcast:8 row_mask:0xf bank_mask:0xf
    v_and_b32_dpp v21, v67, v5 row_newbcast:8 row_mask:0xf bank_mask:0xf
    v_and_b32_dpp v22, v67, v6 row_newbcast:8 row_mask:0xf bank_mask:0xf
    v_and_b32_dpp v23, v67, v7 row_newbcast:8 row_mask:0xf bank_mask:0xf
    v_mfma_f32_16x16x32_bf16 v[12:15], v[16:19], a[40:43], v[12:15]
    v_and_b32_dpp v16, v64, v4 row_newbcast:12 row_mask:0xf bank_mask:0xf
    v_and_b32_dpp v17, v64, v5 row_newbcast:12 row_mask:0xf bank_mask:0xf
    v_and_b32_dpp v18, v64, v6 row_newbcast:12 row_mask:0xf bank_mask:0xf
    v_and_b32_dpp v19, v64, v7 row_newbcast:12 row_mask:0xf bank_mask:0xf
    v_mfma_f32_16x16x32_bf16 v[12:15], v[20:23], a[44:47], v[12:15]
    s_waitcnt vmcnt(7)
    s_xor_b32 s58, s57, 208896
    buffer_load_dwordx4 a[204:207], v1, s[20:23], s58 offen offset:0 nt
    v_and_b32_dpp v20, v65, v4 row_newbcast:12 row_mask:0xf bank_mask:0xf
    v_and_b32_dpp v21, v65, v5 row_newbcast:12 row_mask:0xf bank_mask:0xf
    v_and_b32_dpp v22, v65, v6 row_newbcast:12 row_mask:0xf bank_mask:0xf
    v_and_b32_dpp v23, v65, v7 row_newbcast:12 row_mask:0xf bank_mask:0xf
    v_mfma_f32_16x16x32_bf16 v[12:15], v[16:19], a[48:51], v[12:15]
    v_and_b32_dpp v16, v66, v4 row_newbcast:12 row_mask:0xf bank_mask:0xf
    v_and_b32_dpp v17, v66, v5 row_newbcast:12 row_mask:0xf bank_mask:0xf
    v_and_b32_dpp v18, v66, v6 row_newbcast:12 row_mask:0xf bank_mask:0xf
    v_and_b32_dpp v19, v66, v7 row_newbcast:12 row_mask:0xf bank_mask:0xf
    v_mfma_f32_16x16x32_bf16 v[12:15], v[20:23], a[52:55], v[12:15]
    v_and_b32_dpp v20, v67, v4 row_newbcast:12 row_mask:0xf bank_mask:0xf
    v_and_b32_dpp v21, v67, v5 row_newbcast:12 row_mask:0xf bank_mask:0xf
    v_and_b32_dpp v22, v67, v6 row_newbcast:12 row_mask:0xf bank_mask:0xf
    v_and_b32_dpp v23, v67, v7 row_newbcast:12 row_mask:0xf bank_mask:0xf
    v_mfma_f32_16x16x32_bf16 v[12:15], v[16:19], a[56:59], v[12:15]
    v_and_b32_dpp v16, v68, v4 row_newbcast:0 row_mask:0xf bank_mask:0xf
    v_and_b32_dpp v17, v68, v5 row_newbcast:0 row_mask:0xf bank_mask:0xf
    v_and_b32_dpp v18, v68, v6 row_newbcast:0 row_mask:0xf bank_mask:0xf
    v_and_b32_dpp v19, v68, v7 row_newbcast:0 row_mask:0xf bank_mask:0xf
    v_mfma_f32_16x16x32_bf16 v[12:15], v[20:23], a[60:63], v[12:15]
    v_and_b32_dpp v20, v69, v4 row_newbcast:0 row_mask:0xf bank_mask:0xf
    v_and_b32_dpp v21, v69, v5 row_newbcast:0 row_mask:0xf bank_mask:0xf
    v_and_b32_dpp v22, v69, v6 row_newbcast:0 row_mask:0xf bank_mask:0xf
    v_and_b32_dpp v23, v69, v7 row_newbcast:0 row_mask:0xf bank_mask:0xf
    v_mfma_f32_16x16x32_bf16 v[12:15], v[16:19], a[64:67], v[12:15]
    v_and_b32_dpp v16, v70, v4 row_newbcast:0 row_mask:0xf bank_mask:0xf
    v_and_b32_dpp v17, v70, v5 row_newbcast:0 row_mask:0xf bank_mask:0xf
    v_and_b32_dpp v18, v70, v6 row_newbcast:0 row_mask:0xf bank_mask:0xf
    v_and_b32_dpp v19, v70, v7 row_newbcast:0 row_mask:0xf bank_mask:0xf
    v_mfma_f32_16x16x32_bf16 v[12:15], v[20:23], a[68:71], v[12:15]
    s_waitcnt vmcnt(7)
    s_xor_b32 s58, s57, 212992
    buffer_load_dwordx4 a[208:211], v1, s[20:23], s58 offen offset:0 nt
    v_and_b32_dpp v20, v71, v4 row_newbcast:0 row_mask:0xf bank_mask:0xf
    v_and_b32_dpp v21, v71, v5 row_newbcast:0 row_mask:0xf bank_mask:0xf
    v_and_b32_dpp v22, v71, v6 row_newbcast:0 row_mask:0xf bank_mask:0xf
    v_and_b32_dpp v23, v71, v7 row_newbcast:0 row_mask:0xf bank_mask:0xf
    v_mfma_f32_16x16x32_bf16 v[12:15], v[16:19], a[72:75], v[12:15]
    v_and_b32_dpp v16, v68, v4 row_newbcast:4 row_mask:0xf bank_mask:0xf
    v_and_b32_dpp v17, v68, v5 row_newbcast:4 row_mask:0xf bank_mask:0xf
    v_and_b32_dpp v18, v68, v6 row_newbcast:4 row_mask:0xf bank_mask:0xf
    v_and_b32_dpp v19, v68, v7 row_newbcast:4 row_mask:0xf bank_mask:0xf
    v_mfma_f32_16x16x32_bf16 v[12:15], v[20:23], a[76:79], v[12:15]
    v_and_b32_dpp v20, v69, v4 row_newbcast:4 row_mask:0xf bank_mask:0xf
    v_and_b32_dpp v21, v69, v5 row_newbcast:4 row_mask:0xf bank_mask:0xf
    v_and_b32_dpp v22, v69, v6 row_newbcast:4 row_mask:0xf bank_mask:0xf
    v_and_b32_dpp v23, v69, v7 row_newbcast:4 row_mask:0xf bank_mask:0xf
    v_mfma_f32_16x16x32_bf16 v[12:15], v[16:19], a[80:83], v[12:15]
    v_and_b32_dpp v16, v70, v4 row_newbcast:4 row_mask:0xf bank_mask:0xf
    v_and_b32_dpp v17, v70, v5 row_newbcast:4 row_mask:0xf bank_mask:0xf
    v_and_b32_dpp v18, v70, v6 row_newbcast:4 row_mask:0xf bank_mask:0xf
    v_and_b32_dpp v19, v70, v7 row_newbcast:4 row_mask:0xf bank_mask:0xf
    v_mfma_f32_16x16x32_bf16 v[12:15], v[20:23], a[84:87], v[12:15]
    v_and_b32_dpp v20, v71, v4 row_newbcast:4 row_mask:0xf bank_mask:0xf
    v_and_b32_dpp v21, v71, v5 row_newbcast:4 row_mask:0xf bank_mask:0xf
    v_and_b32_dpp v22, v71, v6 row_newbcast:4 row_mask:0xf bank_mask:0xf
    v_and_b32_dpp v23, v71, v7 row_newbcast:4 row_mask:0xf bank_mask:0xf
    v_mfma_f32_16x16x32_bf16 v[12:15], v[16:19], a[88:91], v[12:15]
    v_and_b32_dpp v16, v68, v4 row_newbcast:8 row_mask:0xf bank_mask:0xf
    v_and_b32_dpp v17, v68, v5 row_newbcast:8 row_mask:0xf bank_mask:0xf
    v_and_b32_dpp v18, v68, v6 row_newbcast:8 row_mask:0xf bank_mask:0xf
    v_and_b32_dpp v19, v68, v7 row_newbcast:8 row_mask:0xf bank_mask:0xf
    v_mfma_f32_16x16x32_bf16 v[12:15], v[20:23], a[92:95], v[12:15]
    s_waitcnt vmcnt(7)
    s_xor_b32 s58, s57, 217088
    buffer_load_dwordx4 a[212:215], v1, s[20:23], s58 offen offset:0 nt
    v_and_b32_dpp v20, v69, v4 row_newbcast:8 row_mask:0xf bank_mask:0xf
    v_and_b32_dpp v21, v69, v5 row_newbcast:8 row_mask:0xf bank_mask:0xf
    v_and_b32_dpp v22, v69, v6 row_newbcast:8 row_mask:0xf bank_mask:0xf
    v_and_b32_dpp v23, v69, v7 row_newbcast:8 row_mask:0xf bank_mask:0xf
    v_mfma_f32_16x16x32_bf16 v[12:15], v[16:19], a[96:99], v[12:15]
    v_and_b32_dpp v16, v70, v4 row_newbcast:8 row_mask:0xf bank_mask:0xf
    v_and_b32_dpp v17, v70, v5 row_newbcast:8 row_mask:0xf bank_mask:0xf
    v_and_b32_dpp v18, v70, v6 row_newbcast:8 row_mask:0xf bank_mask:0xf
    v_and_b32_dpp v19, v70, v7 row_newbcast:8 row_mask:0xf bank_mask:0xf
    v_mfma_f32_16x16x32_bf16 v[12:15], v[20:23], a[100:103], v[12:15]
    v_and_b32_dpp v20, v71, v4 row_newbcast:8 row_mask:0xf bank_mask:0xf
    v_and_b32_dpp v21, v71, v5 row_newbcast:8 row_mask:0xf bank_mask:0xf
    v_and_b32_dpp v22, v71, v6 row_newbcast:8 row_mask:0xf bank_mask:0xf
    v_and_b32_dpp v23, v71, v7 row_newbcast:8 row_mask:0xf bank_mask:0xf
    v_mfma_f32_16x16x32_bf16 v[12:15], v[16:19], a[104:107], v[12:15]
    v_and_b32_dpp v16, v68, v4 row_newbcast:12 row_mask:0xf bank_mask:0xf
    v_and_b32_dpp v17, v68, v5 row_newbcast:12 row_mask:0xf bank_mask:0xf
    v_and_b32_dpp v18, v68, v6 row_newbcast:12 row_mask:0xf bank_mask:0xf
    v_and_b32_dpp v19, v68, v7 row_newbcast:12 row_mask:0xf bank_mask:0xf
    v_mfma_f32_16x16x32_bf16 v[12:15], v[20:23], a[108:111], v[12:15]
    v_and_b32_dpp v20, v69, v4 row_newbcast:12 row_mask:0xf bank_mask:0xf
    v_and_b32_dpp v21, v69, v5 row_newbcast:12 row_mask:0xf bank_mask:0xf
    v_and_b32_dpp v22, v69, v6 row_newbcast:12 row_mask:0xf bank_mask:0xf
    v_and_b32_dpp v23, v69, v7 row_newbcast:12 row_mask:0xf bank_mask:0xf
    v_mfma_f32_16x16x32_bf16 v[12:15], v[16:19], a[112:115], v[12:15]
    v_and_b32_dpp v16, v70, v4 row_newbcast:12 row_mask:0xf bank_mask:0xf
    v_and_b32_dpp v17, v70, v5 row_newbcast:12 row_mask:0xf bank_mask:0xf
    v_and_b32_dpp v18, v70, v6 row_newbcast:12 row_mask:0xf bank_mask:0xf
    v_and_b32_dpp v19, v70, v7 row_newbcast:12 row_mask:0xf bank_mask:0xf
    v_mfma_f32_16x16x32_bf16 v[12:15], v[20:23], a[116:119], v[12:15]
    s_waitcnt vmcnt(7)
    s_xor_b32 s58, s57, 221184
    buffer_load_dwordx4 a[216:219], v1, s[20:23], s58 offen offset:0 nt
    v_and_b32_dpp v20, v71, v4 row_newbcast:12 row_mask:0xf bank_mask:0xf
    v_and_b32_dpp v21, v71, v5 row_newbcast:12 row_mask:0xf bank_mask:0xf
    v_and_b32_dpp v22, v71, v6 row_newbcast:12 row_mask:0xf bank_mask:0xf
    v_and_b32_dpp v23, v71, v7 row_newbcast:12 row_mask:0xf bank_mask:0xf
    v_mfma_f32_16x16x32_bf16 v[12:15], v[16:19], a[120:123], v[12:15]
    v_and_b32_dpp v16, v72, v4 row_newbcast:0 row_mask:0xf bank_mask:0xf
    v_and_b32_dpp v17, v72, v5 row_newbcast:0 row_mask:0xf bank_mask:0xf
    v_and_b32_dpp v18, v72, v6 row_newbcast:0 row_mask:0xf bank_mask:0xf
    v_and_b32_dpp v19, v72, v7 row_newbcast:0 row_mask:0xf bank_mask:0xf
    v_mfma_f32_16x16x32_bf16 v[12:15], v[20:23], a[124:127], v[12:15]
    v_and_b32_dpp v20, v73, v4 row_newbcast:0 row_mask:0xf bank_mask:0xf
    v_and_b32_dpp v21, v73, v5 row_newbcast:0 row_mask:0xf bank_mask:0xf
    v_and_b32_dpp v22, v73, v6 row_newbcast:0 row_mask:0xf bank_mask:0xf
    v_and_b32_dpp v23, v73, v7 row_newbcast:0 row_mask:0xf bank_mask:0xf
    v_mfma_f32_16x16x32_bf16 v[12:15], v[16:19], a[128:131], v[12:15]
    v_and_b32_dpp v16, v74, v4 row_newbcast:0 row_mask:0xf bank_mask:0xf
    v_and_b32_dpp v17, v74, v5 row_newbcast:0 row_mask:0xf bank_mask:0xf
    v_and_b32_dpp v18, v74, v6 row_newbcast:0 row_mask:0xf bank_mask:0xf
    v_and_b32_dpp v19, v74, v7 row_newbcast:0 row_mask:0xf bank_mask:0xf
    v_mfma_f32_16x16x32_bf16 v[12:15], v[20:23], a[132:135], v[12:15]
    v_and_b32_dpp v20, v75, v4 row_newbcast:0 row_mask:0xf bank_mask:0xf
    v_and_b32_dpp v21, v75, v5 row_newbcast:0 row_mask:0xf bank_mask:0xf
    v_and_b32_dpp v22, v75, v6 row_newbcast:0 row_mask:0xf bank_mask:0xf
    v_and_b32_dpp v23, v75, v7 row_newbcast:0 row_mask:0xf bank_mask:0xf
    v_mfma_f32_16x16x32_bf16 v[12:15], v[16:19], a[136:139], v[12:15]
    v_and_b32_dpp v16, v72, v4 row_newbcast:4 row_mask:0xf bank_mask:0xf
    v_and_b32_dpp v17, v72, v5 row_newbcast:4 row_mask:0xf bank_mask:0xf
    v_and_b32_dpp v18, v72, v6 row_newbcast:4 row_mask:0xf bank_mask:0xf
    v_and_b32_dpp v19, v72, v7 row_newbcast:4 row_mask:0xf bank_mask:0xf
    v_mfma_f32_16x16x32_bf16 v[12:15], v[20:23], a[140:143], v[12:15]
    s_waitcnt vmcnt(7)
    s_xor_b32 s58, s57, 225280
    buffer_load_dwordx4 a[220:223], v1, s[20:23], s58 offen offset:0 nt
    v_and_b32_dpp v20, v73, v4 row_newbcast:4 row_mask:0xf bank_mask:0xf
    v_and_b32_dpp v21, v73, v5 row_newbcast:4 row_mask:0xf bank_mask:0xf
    v_and_b32_dpp v22, v73, v6 row_newbcast:4 row_mask:0xf bank_mask:0xf
    v_and_b32_dpp v23, v73, v7 row_newbcast:4 row_mask:0xf bank_mask:0xf
    v_mfma_f32_16x16x32_bf16 v[12:15], v[16:19], a[144:147], v[12:15]
    v_and_b32_dpp v16, v74, v4 row_newbcast:4 row_mask:0xf bank_mask:0xf
    v_and_b32_dpp v17, v74, v5 row_newbcast:4 row_mask:0xf bank_mask:0xf
    v_and_b32_dpp v18, v74, v6 row_newbcast:4 row_mask:0xf bank_mask:0xf
    v_and_b32_dpp v19, v74, v7 row_newbcast:4 row_mask:0xf bank_mask:0xf
    v_mfma_f32_16x16x32_bf16 v[12:15], v[20:23], a[148:151], v[12:15]
    v_and_b32_dpp v20, v75, v4 row_newbcast:4 row_mask:0xf bank_mask:0xf
    v_and_b32_dpp v21, v75, v5 row_newbcast:4 row_mask:0xf bank_mask:0xf
    v_and_b32_dpp v22, v75, v6 row_newbcast:4 row_mask:0xf bank_mask:0xf
    v_and_b32_dpp v23, v75, v7 row_newbcast:4 row_mask:0xf bank_mask:0xf
    v_mfma_f32_16x16x32_bf16 v[12:15], v[16:19], a[152:155], v[12:15]
    v_and_b32_dpp v16, v72, v4 row_newbcast:8 row_mask:0xf bank_mask:0xf
    v_and_b32_dpp v17, v72, v5 row_newbcast:8 row_mask:0xf bank_mask:0xf
    v_and_b32_dpp v18, v72, v6 row_newbcast:8 row_mask:0xf bank_mask:0xf
    v_and_b32_dpp v19, v72, v7 row_newbcast:8 row_mask:0xf bank_mask:0xf
    v_mfma_f32_16x16x32_bf16 v[12:15], v[20:23], a[156:159], v[12:15]
    v_and_b32_dpp v20, v73, v4 row_newbcast:8 row_mask:0xf bank_mask:0xf
    v_and_b32_dpp v21, v73, v5 row_newbcast:8 row_mask:0xf bank_mask:0xf
    v_and_b32_dpp v22, v73, v6 row_newbcast:8 row_mask:0xf bank_mask:0xf
    v_and_b32_dpp v23, v73, v7 row_newbcast:8 row_mask:0xf bank_mask:0xf
    v_mfma_f32_16x16x32_bf16 v[12:15], v[16:19], a[160:163], v[12:15]
    v_and_b32_dpp v16, v74, v4 row_newbcast:8 row_mask:0xf bank_mask:0xf
    v_and_b32_dpp v17, v74, v5 row_newbcast:8 row_mask:0xf bank_mask:0xf
    v_and_b32_dpp v18, v74, v6 row_newbcast:8 row_mask:0xf bank_mask:0xf
    v_and_b32_dpp v19, v74, v7 row_newbcast:8 row_mask:0xf bank_mask:0xf
    v_mfma_f32_16x16x32_bf16 v[12:15], v[20:23], a[164:167], v[12:15]
    s_waitcnt vmcnt(7)
    s_xor_b32 s58, s57, 229376
    buffer_load_dwordx4 a[224:227], v1, s[20:23], s58 offen offset:0 nt
    v_and_b32_dpp v20, v75, v4 row_newbcast:8 row_mask:0xf bank_mask:0xf
    v_and_b32_dpp v21, v75, v5 row_newbcast:8 row_mask:0xf bank_mask:0xf
    v_and_b32_dpp v22, v75, v6 row_newbcast:8 row_mask:0xf bank_mask:0xf
    v_and_b32_dpp v23, v75, v7 row_newbcast:8 row_mask:0xf bank_mask:0xf
    v_mfma_f32_16x16x32_bf16 v[12:15], v[16:19], a[168:171], v[12:15]
    v_and_b32_dpp v16, v72, v4 row_newbcast:12 row_mask:0xf bank_mask:0xf
    v_and_b32_dpp v17, v72, v5 row_newbcast:12 row_mask:0xf bank_mask:0xf
    v_and_b32_dpp v18, v72, v6 row_newbcast:12 row_mask:0xf bank_mask:0xf
    v_and_b32_dpp v19, v72, v7 row_newbcast:12 row_mask:0xf bank_mask:0xf
    v_mfma_f32_16x16x32_bf16 v[12:15], v[20:23], a[172:175], v[12:15]
    v_and_b32_dpp v20, v73, v4 row_newbcast:12 row_mask:0xf bank_mask:0xf
    v_and_b32_dpp v21, v73, v5 row_newbcast:12 row_mask:0xf bank_mask:0xf
    v_and_b32_dpp v22, v73, v6 row_newbcast:12 row_mask:0xf bank_mask:0xf
    v_and_b32_dpp v23, v73, v7 row_newbcast:12 row_mask:0xf bank_mask:0xf
    v_mfma_f32_16x16x32_bf16 v[12:15], v[16:19], a[176:179], v[12:15]
    v_and_b32_dpp v16, v74, v4 row_newbcast:12 row_mask:0xf bank_mask:0xf
    v_and_b32_dpp v17, v74, v5 row_newbcast:12 row_mask:0xf bank_mask:0xf
    v_and_b32_dpp v18, v74, v6 row_newbcast:12 row_mask:0xf bank_mask:0xf
    v_and_b32_dpp v19, v74, v7 row_newbcast:12 row_mask:0xf bank_mask:0xf
    v_mfma_f32_16x16x32_bf16 v[12:15], v[20:23], a[180:183], v[12:15]
    v_and_b32_dpp v20, v75, v4 row_newbcast:12 row_mask:0xf bank_mask:0xf
    v_and_b32_dpp v21, v75, v5 row_newbcast:12 row_mask:0xf bank_mask:0xf
    v_and_b32_dpp v22, v75, v6 row_newbcast:12 row_mask:0xf bank_mask:0xf
    v_and_b32_dpp v23, v75, v7 row_newbcast:12 row_mask:0xf bank_mask:0xf
    v_mfma_f32_16x16x32_bf16 v[12:15], v[16:19], a[184:187], v[12:15]
    v_and_b32_dpp v16, v76, v4 row_newbcast:0 row_mask:0xf bank_mask:0xf
    v_and_b32_dpp v17, v76, v5 row_newbcast:0 row_mask:0xf bank_mask:0xf
    v_and_b32_dpp v18, v76, v6 row_newbcast:0 row_mask:0xf bank_mask:0xf
    v_and_b32_dpp v19, v76, v7 row_newbcast:0 row_mask:0xf bank_mask:0xf
    v_mfma_f32_16x16x32_bf16 v[12:15], v[20:23], a[188:191], v[12:15]
    s_waitcnt vmcnt(7)
    s_xor_b32 s58, s57, 233472
    buffer_load_dwordx4 a[228:231], v1, s[20:23], s58 offen offset:0 nt
    v_and_b32_dpp v20, v77, v4 row_newbcast:0 row_mask:0xf bank_mask:0xf
    v_and_b32_dpp v21, v77, v5 row_newbcast:0 row_mask:0xf bank_mask:0xf
    v_and_b32_dpp v22, v77, v6 row_newbcast:0 row_mask:0xf bank_mask:0xf
    v_and_b32_dpp v23, v77, v7 row_newbcast:0 row_mask:0xf bank_mask:0xf
    v_mfma_f32_16x16x32_bf16 v[12:15], v[16:19], a[192:195], v[12:15]
    v_and_b32_dpp v16, v78, v4 row_newbcast:0 row_mask:0xf bank_mask:0xf
    v_and_b32_dpp v17, v78, v5 row_newbcast:0 row_mask:0xf bank_mask:0xf
    v_and_b32_dpp v18, v78, v6 row_newbcast:0 row_mask:0xf bank_mask:0xf
    v_and_b32_dpp v19, v78, v7 row_newbcast:0 row_mask:0xf bank_mask:0xf
    v_mfma_f32_16x16x32_bf16 v[12:15], v[20:23], a[196:199], v[12:15]
    v_and_b32_dpp v20, v79, v4 row_newbcast:0 row_mask:0xf bank_mask:0xf
    v_and_b32_dpp v21, v79, v5 row_newbcast:0 row_mask:0xf bank_mask:0xf
    v_and_b32_dpp v22, v79, v6 row_newbcast:0 row_mask:0xf bank_mask:0xf
    v_and_b32_dpp v23, v79, v7 row_newbcast:0 row_mask:0xf bank_mask:0xf
    s_waitcnt vmcnt(7)
    v_mfma_f32_16x16x32_bf16 v[12:15], v[16:19], a[200:203], v[12:15]
    s_xor_b32 s58, s57, 237568
    buffer_load_dwordx4 a[232:235], v1, s[20:23], s58 offen offset:0 nt
    v_and_b32_dpp v16, v76, v4 row_newbcast:4 row_mask:0xf bank_mask:0xf
    v_and_b32_dpp v17, v76, v5 row_newbcast:4 row_mask:0xf bank_mask:0xf
    v_and_b32_dpp v18, v76, v6 row_newbcast:4 row_mask:0xf bank_mask:0xf
    v_and_b32_dpp v19, v76, v7 row_newbcast:4 row_mask:0xf bank_mask:0xf
    s_waitcnt vmcnt(7)
    v_mfma_f32_16x16x32_bf16 v[12:15], v[20:23], a[204:207], v[12:15]
    s_xor_b32 s58, s57, 241664
    buffer_load_dwordx4 a[236:239], v1, s[20:23], s58 offen offset:0 nt
    v_and_b32_dpp v20, v77, v4 row_newbcast:4 row_mask:0xf bank_mask:0xf
    v_and_b32_dpp v21, v77, v5 row_newbcast:4 row_mask:0xf bank_mask:0xf
    v_and_b32_dpp v22, v77, v6 row_newbcast:4 row_mask:0xf bank_mask:0xf
    v_and_b32_dpp v23, v77, v7 row_newbcast:4 row_mask:0xf bank_mask:0xf
    s_waitcnt vmcnt(7)
    v_mfma_f32_16x16x32_bf16 v[12:15], v[16:19], a[208:211], v[12:15]
    s_xor_b32 s58, s57, 245760
    buffer_load_dwordx4 a[240:243], v1, s[20:23], s58 offen offset:0 nt
    v_and_b32_dpp v16, v78, v4 row_newbcast:4 row_mask:0xf bank_mask:0xf
    v_and_b32_dpp v17, v78, v5 row_newbcast:4 row_mask:0xf bank_mask:0xf
    v_and_b32_dpp v18, v78, v6 row_newbcast:4 row_mask:0xf bank_mask:0xf
    v_and_b32_dpp v19, v78, v7 row_newbcast:4 row_mask:0xf bank_mask:0xf
    s_waitcnt vmcnt(7)
    v_mfma_f32_16x16x32_bf16 v[12:15], v[20:23], a[212:215], v[12:15]
    s_xor_b32 s58, s57, 249856
    buffer_load_dwordx4 a[244:247], v1, s[20:23], s58 offen offset:0 nt
    v_and_b32_dpp v20, v79, v4 row_newbcast:4 row_mask:0xf bank_mask:0xf
    v_and_b32_dpp v21, v79, v5 row_newbcast:4 row_mask:0xf bank_mask:0xf
    v_and_b32_dpp v22, v79, v6 row_newbcast:4 row_mask:0xf bank_mask:0xf
    v_and_b32_dpp v23, v79, v7 row_newbcast:4 row_mask:0xf bank_mask:0xf
    s_waitcnt vmcnt(7)
    v_mfma_f32_16x16x32_bf16 v[12:15], v[16:19], a[216:219], v[12:15]
    s_xor_b32 s58, s57, 253952
    buffer_load_dwordx4 a[248:251], v1, s[20:23], s58 offen offset:0 nt
    v_and_b32_dpp v16, v76, v4 row_newbcast:8 row_mask:0xf bank_mask:0xf
    v_and_b32_dpp v17, v76, v5 row_newbcast:8 row_mask:0xf bank_mask:0xf
    v_and_b32_dpp v18, v76, v6 row_newbcast:8 row_mask:0xf bank_mask:0xf
    v_and_b32_dpp v19, v76, v7 row_newbcast:8 row_mask:0xf bank_mask:0xf
    s_waitcnt vmcnt(7)
    v_mfma_f32_16x16x32_bf16 v[12:15], v[20:23], a[220:223], v[12:15]
    s_xor_b32 s58, s57, 258048
    buffer_load_dwordx4 a[252:255], v1, s[20:23], s58 offen offset:0 nt
    s_mov_b32 m0, s55
    s_mov_b32 s53, 0
    buffer_load_dwordx4 v82, s[24:27], s53 offen nt lds
    s_add_u32 s55, s55, 1024
    s_mov_b32 m0, s55
    s_mov_b32 s53, 8192
    buffer_load_dwordx4 v82, s[24:27], s53 offen nt lds
    s_add_u32 s55, s55, 1024
    s_mov_b32 m0, s55
    s_mov_b32 s53, 16384
    buffer_load_dwordx4 v82, s[24:27], s53 offen nt lds
    s_add_u32 s55, s55, 1024
    s_mov_b32 m0, s55
    s_mov_b32 s53, 24576
    buffer_load_dwordx4 v82, s[24:27], s53 offen nt lds
    buffer_load_dwordx4 v[128:131], v80, s[40:43], 0 offen sc1
    buffer_load_dwordx4 v[132:135], v80, s[40:43], s66 offen sc1
    buffer_load_dwordx4 v[136:139], v81, s[40:43], s67 offen sc1
    buffer_load_ushort v90, v63, s[8:11], 0 offen
    v_and_b32_dpp v20, v77, v4 row_newbcast:8 row_mask:0xf bank_mask:0xf
    v_and_b32_dpp v21, v77, v5 row_newbcast:8 row_mask:0xf bank_mask:0xf
    v_and_b32_dpp v22, v77, v6 row_newbcast:8 row_mask:0xf bank_mask:0xf
    v_and_b32_dpp v23, v77, v7 row_newbcast:8 row_mask:0xf bank_mask:0xf
    s_waitcnt vmcnt(15)
    v_mfma_f32_16x16x32_bf16 v[12:15], v[16:19], a[224:227], v[12:15]
    v_and_b32_dpp v16, v78, v4 row_newbcast:8 row_mask:0xf bank_mask:0xf
    v_and_b32_dpp v17, v78, v5 row_newbcast:8 row_mask:0xf bank_mask:0xf
    v_and_b32_dpp v18, v78, v6 row_newbcast:8 row_mask:0xf bank_mask:0xf
    v_and_b32_dpp v19, v78, v7 row_newbcast:8 row_mask:0xf bank_mask:0xf
    s_waitcnt vmcnt(14)
    v_mfma_f32_16x16x32_bf16 v[12:15], v[20:23], a[228:231], v[12:15]
    v_and_b32_dpp v20, v79, v4 row_newbcast:8 row_mask:0xf bank_mask:0xf
    v_and_b32_dpp v21, v79, v5 row_newbcast:8 row_mask:0xf bank_mask:0xf
    v_and_b32_dpp v22, v79, v6 row_newbcast:8 row_mask:0xf bank_mask:0xf
    v_and_b32_dpp v23, v79, v7 row_newbcast:8 row_mask:0xf bank_mask:0xf
    s_waitcnt vmcnt(13)
    v_mfma_f32_16x16x32_bf16 v[12:15], v[16:19], a[232:235], v[12:15]
    v_and_b32_dpp v16, v76, v4 row_newbcast:12 row_mask:0xf bank_mask:0xf
    v_and_b32_dpp v17, v76, v5 row_newbcast:12 row_mask:0xf bank_mask:0xf
    v_and_b32_dpp v18, v76, v6 row_newbcast:12 row_mask:0xf bank_mask:0xf
    v_and_b32_dpp v19, v76, v7 row_newbcast:12 row_mask:0xf bank_mask:0xf
    s_waitcnt vmcnt(12)
    v_mfma_f32_16x16x32_bf16 v[12:15], v[20:23], a[236:239], v[12:15]
    v_and_b32_dpp v20, v77, v4 row_newbcast:12 row_mask:0xf bank_mask:0xf
    v_and_b32_dpp v21, v77, v5 row_newbcast:12 row_mask:0xf bank_mask:0xf
    v_and_b32_dpp v22, v77, v6 row_newbcast:12 row_mask:0xf bank_mask:0xf
    v_and_b32_dpp v23, v77, v7 row_newbcast:12 row_mask:0xf bank_mask:0xf
    s_waitcnt vmcnt(11)
    v_mfma_f32_16x16x32_bf16 v[12:15], v[16:19], a[240:243], v[12:15]
    v_and_b32_dpp v16, v78, v4 row_newbcast:12 row_mask:0xf bank_mask:0xf
    v_and_b32_dpp v17, v78, v5 row_newbcast:12 row_mask:0xf bank_mask:0xf
    v_and_b32_dpp v18, v78, v6 row_newbcast:12 row_mask:0xf bank_mask:0xf
    v_and_b32_dpp v19, v78, v7 row_newbcast:12 row_mask:0xf bank_mask:0xf
    s_waitcnt vmcnt(10)
    v_mfma_f32_16x16x32_bf16 v[12:15], v[20:23], a[244:247], v[12:15]
    v_and_b32_dpp v20, v79, v4 row_newbcast:12 row_mask:0xf bank_mask:0xf
    v_and_b32_dpp v21, v79, v5 row_newbcast:12 row_mask:0xf bank_mask:0xf
    v_and_b32_dpp v22, v79, v6 row_newbcast:12 row_mask:0xf bank_mask:0xf
    v_and_b32_dpp v23, v79, v7 row_newbcast:12 row_mask:0xf bank_mask:0xf
    s_waitcnt vmcnt(9)
    v_mfma_f32_16x16x32_bf16 v[12:15], v[16:19], a[248:251], v[12:15]
    s_waitcnt vmcnt(8)
    v_mfma_f32_16x16x32_bf16 v[12:15], v[20:23], a[252:255], v[12:15]
    s_mov_b64 exec, 0xffffffff
    s_nop 6
    ds_write_b128 v51, v[12:15] offset:3584
    s_mov_b64 exec, -1
    s_waitcnt lgkmcnt(0)
    s_barrier
    ds_read_b128 v[160:163], v62 offset:3584
    ds_read_b128 v[164:167], v62 offset:4096
    ds_read_b128 v[168:171], v62 offset:4608
    ds_read_b128 v[172:175], v62 offset:5120
    s_waitcnt lgkmcnt(2)
    v_pk_add_f32 v[160:161], v[160:161], v[164:165]
    v_pk_add_f32 v[162:163], v[162:163], v[166:167]
    s_waitcnt lgkmcnt(1)
    v_pk_add_f32 v[160:161], v[160:161], v[168:169]
    v_pk_add_f32 v[162:163], v[162:163], v[170:171]
    s_waitcnt lgkmcnt(0)
    v_pk_add_f32 v[160:161], v[160:161], v[172:173]
    v_pk_add_f32 v[162:163], v[162:163], v[174:175]
    v_bfi_b32 v160, s64, v160, v56
    v_bfi_b32 v161, s64, v161, v57
    v_bfi_b32 v162, s64, v162, v58
    v_bfi_b32 v163, s64, v163, v59
    s_mov_b64 exec, 0xffffffff
    s_cmp_eq_u64 s[76:77], 0
    s_cbranch_scc0 L_far
    buffer_store_dwordx4 v[160:163], v49, s[40:43], 0 offen offset:0
    s_branch L_near
L_far:
    buffer_store_dwordx4 v[160:163], v49, s[40:43], 0 offen offset:0 sc1
L_near:
    s_mov_b64 exec, -1
    s_cmp_eq_u32 s3, 0
    s_cbranch_scc0 L_nop1
    buffer_load_dwordx4 v[196:199], v84, s[40:43], 0 offen offset:0 sc1
    buffer_load_dwordx4 v[200:203], v84, s[40:43], 0 offen offset:1024 sc1
    buffer_load_dwordx4 v[204:207], v84, s[40:43], 0 offen offset:2048 sc1
    buffer_load_dwordx4 v[208:211], v84, s[40:43], 0 offen offset:3072 sc1
    s_waitcnt vmcnt(5)
    s_branch L_nop2
L_nop1:
    s_waitcnt vmcnt(1)
L_nop2:
    s_barrier
    ds_read_b64_tr_b16 v[24:25], v83 offset:5632
    ds_read_b64_tr_b16 v[26:27], v83 offset:6144
    ds_read_b64_tr_b16 v[28:29], v83 offset:9728
    ds_read_b64_tr_b16 v[30:31], v83 offset:10240
    ds_read_b64_tr_b16 v[32:33], v83 offset:13824
    ds_read_b64_tr_b16 v[34:35], v83 offset:14336
    ds_read_b64_tr_b16 v[36:37], v83 offset:17920
    ds_read_b64_tr_b16 v[38:39], v83 offset:18432
    s_cmp_eq_u32 s3, 0
    s_cbranch_scc0 L_got1
L_poll1:
    s_waitcnt vmcnt(3)
    v_xor_b32 v3, v196, v56
    v_xor_b32 v40, v197, v57
    v_bitop3_b32 v3, v198, v58, v3 bitop3:0xbe
    v_bitop3_b32 v40, v199, v59, v40 bitop3:0xbe
    v_and_b32 v212, s64, v196
    v_and_b32 v213, s64, v197
    v_and_b32 v214, s64, v198
    v_and_b32 v215, s64, v199
    s_waitcnt vmcnt(2)
    v_bitop3_b32 v3, v200, v56, v3 bitop3:0xbe
    v_bitop3_b32 v40, v201, v57, v40 bitop3:0xbe
    v_bitop3_b32 v3, v202, v58, v3 bitop3:0xbe
    v_bitop3_b32 v40, v203, v59, v40 bitop3:0xbe
    v_and_b32 v216, s64, v200
    v_and_b32 v217, s64, v201
    v_and_b32 v218, s64, v202
    v_and_b32 v219, s64, v203
    s_waitcnt vmcnt(1)
    v_bitop3_b32 v3, v204, v56, v3 bitop3:0xbe
    v_bitop3_b32 v40, v205, v57, v40 bitop3:0xbe
    v_bitop3_b32 v3, v206, v58, v3 bitop3:0xbe
    v_bitop3_b32 v40, v207, v59, v40 bitop3:0xbe
    v_and_b32 v220, s64, v204
    v_and_b32 v221, s64, v205
    v_and_b32 v222, s64, v206
    v_and_b32 v223, s64, v207
    s_waitcnt vmcnt(0)
    v_bitop3_b32 v3, v208, v56, v3 bitop3:0xbe
    v_bitop3_b32 v40, v209, v57, v40 bitop3:0xbe
    v_bitop3_b32 v3, v210, v58, v3 bitop3:0xbe
    v_bitop3_b32 v40, v211, v59, v40 bitop3:0xbe
    v_or_b32 v3, v3, v40
    v_and_b32 v224, s64, v208
    v_and_b32 v3, 0xff, v3
    v_and_b32 v225, s64, v209
    v_cmp_ne_u32 vcc, 0, v3
    v_and_b32 v226, s64, v210
    v_and_b32 v227, s64, v211
    s_and_b64 exec, exec, vcc
    s_cbranch_scc0 L_got0
    buffer_load_dwordx4 v[196:199], v84, s[40:43], 0 offen offset:0 sc1
    buffer_load_dwordx4 v[200:203], v84, s[40:43], 0 offen offset:1024 sc1
    buffer_load_dwordx4 v[204:207], v84, s[40:43], 0 offen offset:2048 sc1
    buffer_load_dwordx4 v[208:211], v84, s[40:43], 0 offen offset:3072 sc1
    s_sub_u32 s81, s81, 1
    s_cbranch_scc0 L_poll1
    s_branch L_end
L_got0:
    s_mov_b64 exec, -1
    v_pk_add_f32 v[212:213], v[212:213], v[216:217]
    v_pk_add_f32 v[214:215], v[214:215], v[218:219]
    v_pk_add_f32 v[220:221], v[220:221], v[224:225]
    v_pk_add_f32 v[222:223], v[222:223], v[226:227]
    v_pk_add_f32 v[212:213], v[212:213], v[220:221]
    v_pk_add_f32 v[214:215], v[214:215], v[222:223]
    s_nop 1
    v_permlane32_swap_b32 v212, v214
    v_permlane32_swap_b32 v213, v215
    v_pk_add_f32 v[212:213], v[212:213], v[214:215]
    v_cvt_pk_bf16_f32 v212, v212, v213
    ds_write_b32 v85, v212 offset:22016
    s_waitcnt lgkmcnt(0)
L_got1:
    s_barrier
    ds_read_b128 v[180:183], v86 offset:22016
    ds_read_b128 v[184:187], v86 offset:22080
    ds_read_b128 v[188:191], v86 offset:22144
    ds_read_b128 v[192:195], v86 offset:22208
    s_waitcnt lgkmcnt(3)
    v_mfma_f32_16x16x32_bf16 v[12:15], v[24:27], v[180:183], 0
    s_waitcnt lgkmcnt(2)
    v_mfma_f32_16x16x32_bf16 v[12:15], v[28:31], v[184:187], v[12:15]
    s_waitcnt lgkmcnt(1)
    v_mfma_f32_16x16x32_bf16 v[12:15], v[32:35], v[188:191], v[12:15]
    s_waitcnt lgkmcnt(0)
    v_mfma_f32_16x16x32_bf16 v[12:15], v[36:39], v[192:195], v[12:15]
    s_nop 7
    v_bfi_b32 v12, s64, v12, v56
    v_bfi_b32 v13, s64, v13, v57
    v_bfi_b32 v14, s64, v14, v58
    v_bfi_b32 v15, s64, v15, v59
    s_mov_b32 exec_lo, 0x00010001
    s_mov_b32 exec_hi, 0x00010001
    buffer_store_dwordx4 v[12:15], v53, s[40:43], 0 offen sc1
    s_mov_b64 exec, -1
    s_cmp_eq_u32 s80, 0
    s_cbranch_scc0 L_fin
    buffer_load_dwordx4 v[144:147], v52, s[40:43], 0 offen sc1
    buffer_load_dwordx4 v[148:151], v52, s[40:43], 0 offen offset:1024 sc1
    s_waitcnt vmcnt(3)
L_g_chk:
    v_xor_b32 v3, v136, v56
    v_bitop3_b32 v3, v137, v57, v3 bitop3:0xbe
    v_bitop3_b32 v3, v138, v58, v3 bitop3:0xbe
    v_bitop3_b32 v3, v139, v59, v3 bitop3:0xbe
    v_cmp_gt_u32 vcc, 44, v0
    s_nop 1
    v_cndmask_b32 v3, 0, v3, vcc
    v_bitop3_b32 v3, v128, v56, v3 bitop3:0xbe
    v_bitop3_b32 v3, v129, v57, v3 bitop3:0xbe
    v_bitop3_b32 v3, v130, v58, v3 bitop3:0xbe
    v_bitop3_b32 v3, v131, v59, v3 bitop3:0xbe
    v_bitop3_b32 v3, v132, v56, v3 bitop3:0xbe
    v_bitop3_b32 v3, v133, v57, v3 bitop3:0xbe
    v_bitop3_b32 v3, v134, v58, v3 bitop3:0xbe
    v_bitop3_b32 v3, v135, v59, v3 bitop3:0xbe
    v_and_b32 v3, 0xff, v3
    v_cmp_ne_u32 vcc, 0, v3
    s_cbranch_vccz L_g_ok
L_g_re:
    s_waitcnt vmcnt(0)
    buffer_load_dwordx4 v[128:131], v80, s[40:43], 0 offen sc1
    buffer_load_dwordx4 v[132:135], v80, s[40:43], s66 offen sc1
    buffer_load_dwordx4 v[136:139], v81, s[40:43], s67 offen sc1
    buffer_load_dwordx4 v[144:147], v52, s[40:43], 0 offen sc1
    buffer_load_dwordx4 v[148:151], v52, s[40:43], 0 offen offset:1024 sc1
    s_sub_u32 s81, s81, 1
    s_cbranch_scc1 L_end
    s_waitcnt vmcnt(2)
    s_branch L_g_chk
L_g_ok:
    v_and_b32 v128, s64, v128
    v_and_b32 v129, s64, v129
    v_and_b32 v130, s64, v130
    v_and_b32 v131, s64, v131
    v_and_b32 v132, s64, v132
    v_and_b32 v133, s64, v133
    v_and_b32 v134, s64, v134
    v_and_b32 v135, s64, v135
    v_and_b32 v136, s64, v136
    v_and_b32 v137, s64, v137
    v_and_b32 v138, s64, v138
    v_and_b32 v139, s64, v139
    v_add_f32 v128, v128, v132
    v_add_f32 v129, v129, v133
    v_add_f32 v130, v130, v134
    v_add_f32 v131, v131, v135
    v_add_f32 v128, v128, v136
    v_add_f32 v129, v129, v137
    v_add_f32 v130, v130, v138
    v_add_f32 v131, v131, v139
    s_nop 0
    v_permlane32_swap_b32 v128, v130
    v_permlane32_swap_b32 v129, v131
    v_add_f32 v128, v128, v130
    v_add_f32 v129, v129, v131
    s_nop 1
    v_permlane16_swap_b32 v128, v129
    v_add_f32 v128, v128, v129
    s_nop 1
    v_add_f32_dpp v128, v128, v128 row_ror:4 row_mask:0xf bank_mask:0xf
    s_nop 1
    v_add_f32_dpp v128, v128, v128 row_ror:8 row_mask:0xf bank_mask:0xf
    v_cvt_pk_bf16_f32 v128, v128, v128
    v_lshlrev_b32 v128, 16, v128
    v_mul_f32 v129, s61, v128
    v_exp_f32 v129, v129
    s_nop 0
    v_add_f32 v129, 1.0, v129
    v_rcp_f32 v129, v129
    s_nop 0
    v_mul_f32 v128, v128, v129
    v_cvt_pk_bf16_f32 v128, v128, v128
    v_lshlrev_b32 v41, 16, v128
    v_lshlrev_b32 v42, 16, v90
L_poll2:
    buffer_load_dwordx4 v[152:155], v52, s[40:43], 0 offen sc1
    buffer_load_dwordx4 v[156:159], v52, s[40:43], 0 offen offset:1024 sc1
    s_waitcnt vmcnt(3)
    v_xor_b32 v3, v144, v56
    v_bitop3_b32 v3, v145, v57, v3 bitop3:0xbe
    v_bitop3_b32 v3, v146, v58, v3 bitop3:0xbe
    v_bitop3_b32 v3, v147, v59, v3 bitop3:0xbe
    v_and_b32 v112, s64, v144
    v_and_b32 v113, s64, v145
    v_and_b32 v114, s64, v146
    v_and_b32 v115, s64, v147
    s_waitcnt vmcnt(2)
    v_xor_b32 v40, v148, v56
    v_bitop3_b32 v40, v149, v57, v40 bitop3:0xbe
    v_bitop3_b32 v40, v150, v58, v40 bitop3:0xbe
    v_bitop3_b32 v40, v151, v59, v40 bitop3:0xbe
    v_and_b32 v116, s64, v148
    v_and_b32 v117, s64, v149
    v_and_b32 v118, s64, v150
    v_and_b32 v119, s64, v151
    v_or_b32 v3, v3, v40
    v_and_b32 v3, 0xff, v3
    v_cmp_ne_u32 vcc, 0, v3
    s_and_b64 exec, exec, vcc
    s_cbranch_scc0 L_got2
    buffer_load_dwordx4 v[144:147], v52, s[40:43], 0 offen sc1
    buffer_load_dwordx4 v[148:151], v52, s[40:43], 0 offen offset:1024 sc1
    s_waitcnt vmcnt(3)
    v_xor_b32 v3, v152, v56
    v_bitop3_b32 v3, v153, v57, v3 bitop3:0xbe
    v_bitop3_b32 v3, v154, v58, v3 bitop3:0xbe
    v_bitop3_b32 v3, v155, v59, v3 bitop3:0xbe
    v_and_b32 v112, s64, v152
    v_and_b32 v113, s64, v153
    v_and_b32 v114, s64, v154
    v_and_b32 v115, s64, v155
    s_waitcnt vmcnt(2)
    v_xor_b32 v40, v156, v56
    v_bitop3_b32 v40, v157, v57, v40 bitop3:0xbe
    v_bitop3_b32 v40, v158, v58, v40 bitop3:0xbe
    v_bitop3_b32 v40, v159, v59, v40 bitop3:0xbe
    v_and_b32 v116, s64, v156
    v_and_b32 v117, s64, v157
    v_and_b32 v118, s64, v158
    v_and_b32 v119, s64, v159
    v_or_b32 v3, v3, v40
    v_and_b32 v3, 0xff, v3
    v_cmp_ne_u32 vcc, 0, v3
    s_and_b64 exec, exec, vcc
    s_cbranch_scc0 L_got2
    s_sub_u32 s81, s81, 1
    s_cbranch_scc0 L_poll2
    s_branch L_end
L_got2:
    s_mov_b64 exec, -1
    v_add_f32 v112, v112, v116
    v_add_f32 v113, v113, v117
    v_add_f32 v114, v114, v118
    v_add_f32 v115, v115, v119
    s_nop 0
    v_permlane32_swap_b32 v112, v114
    v_permlane32_swap_b32 v113, v115
    v_add_f32 v112, v112, v114
    v_add_f32 v113, v113, v115
    s_nop 1
    v_permlane16_swap_b32 v112, v113
    v_add_f32 v112, v112, v113
    s_nop 1
    v_add_f32_dpp v112, v112, v112 row_ror:4 row_mask:0xf bank_mask:0xf
    s_nop 1
    v_add_f32_dpp v112, v112, v112 row_ror:8 row_mask:0xf bank_mask:0xf
    v_cvt_pk_bf16_f32 v112, v112, v112
    v_lshlrev_b32 v112, 16, v112
    v_mul_f32 v112, v112, v41
    v_cvt_pk_bf16_f32 v112, v112, v112
    v_lshlrev_b32 v112, 16, v112
    v_add_f32 v112, v112, v42
    v_cvt_pk_bf16_f32 v112, v112, v112
    s_mov_b32 exec_lo, 0x000f000f
    s_mov_b32 exec_hi, 0x000f000f
    buffer_store_short v112, v63, s[44:47], 0 offen
    s_cmp_eq_u32 s75, 0
    s_cbranch_scc0 L_fin
    v_mov_b32 v3, 135168
    v_mov_b32 v40, s82
    s_mov_b64 exec, 1
    buffer_store_dword v40, v3, s[40:43], 0 offen
L_fin:
L_end:
    s_endpgm
.section .rodata,"a"
.p2align 6
.amdhsa_kernel recurrent_scan__mha_block_cached__glu_gated_glu__decode_kernel
  .amdhsa_next_free_vgpr 512
  .amdhsa_next_free_sgpr 102
  .amdhsa_accum_offset 256
  .amdhsa_group_segment_fixed_size 0
  .amdhsa_kernarg_size 96
  .amdhsa_user_sgpr_count 2
  .amdhsa_user_sgpr_kernarg_segment_ptr 1
  .amdhsa_system_sgpr_workgroup_id_x 1
.end_amdhsa_kernel
```
